```python
import torch

def _softmax(x, axis=-1):
    return torch.softmax(x, dim=axis)

def _gelu(x):
    return torch.nn.functional.gelu(x, approximate='tanh')

def _silu(x):
    return torch.nn.functional.silu(x)

def _sigmoid(x):
    return torch.sigmoid(x)

def _layernorm(x, axis=-1, eps=1e-05):
    m = x.mean(dim=axis, keepdim=True)
    v = x.var(dim=axis, keepdim=True, unbiased=False)
    return (x - m) / torch.sqrt(v + eps)

def _scatter_add(tgt, idx, src, axis=0):
    return tgt.clone().index_add_(axis, idx, src)

def _segment_sum(src, seg, n):
    out = torch.zeros((n,) + src.shape[1:], dtype=src.dtype)
    return out.index_add_(0, seg, src)

def _pad(x, pw):
    flat = tuple((v for pair in reversed(pw) for v in pair))
    return torch.nn.functional.pad(x, flat)
kernel_name = 'adaLN_cond__spectral_fnet__dense_activation_relu__prompt'

def setup_inputs():

    _w = lambda a: (lambda t: t.to(torch.bfloat16) if t.is_floating_point() else t)(torch.as_tensor(a))

    def _A_setup():
        B, S, D = (1, 2048, 512)
        ns = torch.arange(S)[:, None] * torch.arange(S)[None, :]
        nd = torch.arange(D)[:, None] * torch.arange(D)[None, :]
        Ws_re = torch.cos(-2.0 * torch.pi * ns / S).to(float)
        Ws_im = torch.sin(-2.0 * torch.pi * ns / S).to(float)
        Wd_re = torch.cos(-2.0 * torch.pi * nd / D).to(float)
        Wd_im = torch.sin(-2.0 * torch.pi * nd / D).to(float)
        return {'x': _w((lambda *s: torch.randn(*s, dtype=torch.bfloat16) * 0.1)(B, S, D)), 'dft_seq_re': _w(Ws_re), 'dft_seq_im': _w(Ws_im), 'dft_hid_re': _w(Wd_re), 'dft_hid_im': _w(Wd_im)}
    _A_in = _A_setup()

    def _B_setup():
        B, S, D, Dff = (1, 2048, 512, 1792)
        return {'x': _w((lambda *s: torch.randn(*s, dtype=torch.bfloat16) * 0.1)(B, S, D)), 'w1': _w((lambda *s: torch.randn(*s, dtype=torch.bfloat16) * 3.2)(D, Dff)), 'w2': _w((lambda *s: torch.randn(*s, dtype=torch.bfloat16) * 3.2)(Dff, D))}
    _B_in = _B_setup()
    return {'A_x': _A_in['x'], 'A_dft_seq_re': _A_in['dft_seq_re'], 'A_dft_seq_im': _A_in['dft_seq_im'], 'A_dft_hid_re': _A_in['dft_hid_re'], 'A_dft_hid_im': _A_in['dft_hid_im'], 'B_x': _B_in['x'], 'B_w1': _B_in['w1'], 'B_w2': _B_in['w2'], 'c': _w((lambda *s: torch.randn(*s, dtype=torch.bfloat16) * 0.4)(1, 512) * 8.0), 'w_mod': _w((lambda *s: torch.randn(*s, dtype=torch.bfloat16) * 0.4)(512, 6 * 512) * 512 ** (-0.5) * 8.0)}

def reference(A_x, A_dft_seq_re, A_dft_seq_im, A_dft_hid_re, A_dft_hid_im, B_x, B_w1, B_w2, c, w_mod):

    def _A_ref(x, dft_seq_re, dft_seq_im, dft_hid_re, dft_hid_im):
        a = torch.einsum('bsd,ed->bse', x, dft_hid_re)
        b = torch.einsum('bsd,ed->bse', x, dft_hid_im)
        y = torch.einsum('ts,bse->bte', dft_seq_re, a) - torch.einsum('ts,bse->bte', dft_seq_im, b)
        return y

    def _B_ref(x, w1, w2):
        h = torch.einsum('bsd,df->bsf', x, w1)
        zero = torch.zeros_like(h)
        h = torch.maximum(h, zero)
        return torch.einsum('bsf,fd->bsd', h, w2)
    x = A_x
    mod = (_silu(c) @ w_mod).reshape(c.shape[0], 6, 1, -1)
    sa, ca, ga, sb, cb, gb = (mod[:, 0].clone(), mod[:, 1].clone(), mod[:, 2].clone(), mod[:, 3].clone(), mod[:, 4].clone(), mod[:, 5].clone())
    h = _layernorm(x, axis=-1) * (1 + ca) + sa
    x = x + ga * _A_ref(h, A_dft_seq_re, A_dft_seq_im, A_dft_hid_re, A_dft_hid_im)
    h = _layernorm(x, axis=-1) * (1 + cb) + sb
    x = x + gb * _B_ref(h, B_w1, B_w2)
    return x
```

```asm
; @launch grid=(256,1,1) block=(256,1,1) lds=163840
.amdgcn_target "amdgcn-amd-amdhsa--gfx950"

.text
.globl adaLN_cond__spectral_fnet__dense_activation_relu__prompt_kernel
.p2align 8
.type adaLN_cond__spectral_fnet__dense_activation_relu__prompt_kernel,@function
adaLN_cond__spectral_fnet__dense_activation_relu__prompt_kernel:
  s_cmp_ge_u32 s2, 256
  s_cbranch_scc1 adaLN_cond__spectral_fnet__dense_activation_relu__prompt_kernel_exit
  s_load_dwordx2 s[36:37], s[0:1], 0
  s_load_dwordx2 s[38:39], s[0:1], 96
  s_load_dwordx2 s[40:41], s[0:1], 56
  s_load_dwordx4 s[44:47], s[0:1], 64
  s_load_dwordx2 s[64:65], s[0:1], 48
  s_getpc_b64 s[42:43]
adaLN_cond__spectral_fnet__dense_activation_relu__prompt_kernel_pc:
  s_add_u32 s42, s42, fnet_tables-adaLN_cond__spectral_fnet__dense_activation_relu__prompt_kernel_pc
  s_addc_u32 s43, s43, 0
  v_lshrrev_b32 v1, 6, v0
  v_and_b32 v0, 63, v0
  v_readfirstlane_b32 s33, v1
  v_lshrrev_b32 v2, 4, v0
  v_and_b32 v3, 15, v0
  s_and_b32 s34, s2, 7
  s_lshr_b32 s35, s2, 4
  s_lshl_b32 s35, s35, 3
  s_add_u32 s34, s34, s35
  s_lshr_b32 s35, s2, 3
  s_and_b32 s35, s35, 1
  v_xor_b32 v4, 0, v0
  v_lshlrev_b32 v4, 4, v4
  v_xor_b32 v5, 1, v0
  v_lshlrev_b32 v5, 4, v5
  v_xor_b32 v6, 8, v0
  v_lshlrev_b32 v6, 4, v6
  v_xor_b32 v7, 9, v0
  v_lshlrev_b32 v7, 4, v7
  s_lshl_b32 s48, s33, 9
  s_add_u32 s48, s48, s34
  s_lshl_b32 s48, s48, 10
  s_lshl_b32 s49, s33, 13
  s_mov_b32 s10, 2097152
  s_mov_b32 s11, 0x20000
  s_mov_b32 m0, s49
  s_cmp_ge_u32 s2, 128
  s_waitcnt lgkmcnt(0)
  s_cbranch_scc1 adaLN_cond__spectral_fnet__dense_activation_relu__prompt_kernel_notA
  s_mov_b32 s8, s36
  s_and_b32 s9, s37, 0xffff
  buffer_load_dwordx4 v4, s[8:11], s48 offen lds
  s_add_u32 s49, s49, 1024
  s_mov_b32 m0, s49
  s_add_u32 s48, s48, 65536
  buffer_load_dwordx4 v5, s[8:11], s48 offen lds
  s_add_u32 s49, s49, 1024
  s_mov_b32 m0, s49
  s_add_u32 s48, s48, 65536
  buffer_load_dwordx4 v6, s[8:11], s48 offen lds
  s_add_u32 s49, s49, 1024
  s_mov_b32 m0, s49
  s_add_u32 s48, s48, 65536
  buffer_load_dwordx4 v7, s[8:11], s48 offen lds
  s_add_u32 s49, s49, 1024
  s_mov_b32 m0, s49
  s_add_u32 s48, s48, 65536
  buffer_load_dwordx4 v4, s[8:11], s48 offen lds
  s_add_u32 s49, s49, 1024
  s_mov_b32 m0, s49
  s_add_u32 s48, s48, 65536
  buffer_load_dwordx4 v5, s[8:11], s48 offen lds
  s_add_u32 s49, s49, 1024
  s_mov_b32 m0, s49
  s_add_u32 s48, s48, 65536
  buffer_load_dwordx4 v6, s[8:11], s48 offen lds
  s_add_u32 s49, s49, 1024
  s_mov_b32 m0, s49
  s_add_u32 s48, s48, 65536
  buffer_load_dwordx4 v7, s[8:11], s48 offen lds
  s_mov_b32 s12, s38
  s_and_b32 s13, s39, 0xffff
  s_mov_b32 s14, 19922944
  s_mov_b32 s15, 0x20000
  s_mov_b32 s20, s42
  s_and_b32 s21, s43, 0xffff
  s_mov_b32 s22, 23552
  s_mov_b32 s23, 0x20000
  s_add_u32 s98, s38, 8491008
  s_addc_u32 s99, s39, 0
  s_load_dword s100, s[98:99], 0
  s_and_b32 s50, s33, 1
  s_lshr_b32 s51, s33, 1
  s_lshl_b32 s52, s50, 11
  v_lshlrev_b32 v8, 5, v0
  buffer_load_dwordx4 v[16:19], v8, s[20:23], s52 offen offset:0
  buffer_load_dwordx4 v[20:23], v8, s[20:23], s52 offen offset:16
  v_lshrrev_b32 v11, 3, v0
  v_and_b32 v12, 7, v0
  s_lshl_b32 s53, s33, 3
  v_add_u32 v13, s53, v11
  v_lshlrev_b32 v14, 10, v13
  v_lshl_add_u32 v14, v12, 4, v14
  v_and_b32 v11, 1, v11
  v_lshl_add_u32 v15, v11, 7, v14
  v_xor_b32 v11, 1, v11
  v_lshl_add_u32 v14, v11, 7, v14
  v_lshlrev_b32 v13, 2, v13
  v_lshrrev_b32 v26, 2, v3
  v_and_b32 v27, 3, v3
  v_lshl_add_u32 v28, v2, 2, v26
  v_lshlrev_b32 v28, 10, v28
  v_and_b32 v29, 1, v26
  v_and_b32 v30, 2, v26
  v_lshl_add_u32 v29, v30, 2, v29
  s_lshl_b32 s53, s35, 5
  s_lshl_b32 s63, s51, 4
  s_add_u32 s53, s53, s63
  v_lshl_add_u32 v27, v27, 1, s53
  v_add_u32 v140, 0, v27
  v_xor_b32 v140, v140, v29
  v_lshl_add_u32 v140, v140, 4, v28
  v_add_u32 v141, 1, v27
  v_xor_b32 v141, v141, v29
  v_lshl_add_u32 v141, v141, 4, v28
  v_add_u32 v142, 8, v27
  v_xor_b32 v142, v142, v29
  v_lshl_add_u32 v142, v142, 4, v28
  v_add_u32 v143, 9, v27
  v_xor_b32 v143, v143, v29
  v_lshl_add_u32 v143, v143, 4, v28
  v_and_b32 v144, 2, v2
  v_lshlrev_b32 v144, 18, v144
  v_and_b32 v27, 3, v3
  v_lshl_add_u32 v144, v27, 9, v144
  v_lshrrev_b32 v27, 2, v3
  v_lshl_add_u32 v144, v27, 4, v144
  v_and_b32 v27, 1, v2
  v_lshl_add_u32 v144, v27, 6, v144
  s_lshl_b32 s76, s50, 20
  s_lshl_b32 s53, s34, 11
  s_add_u32 s76, s76, s53
  s_lshl_b32 s53, s35, 8
  s_add_u32 s76, s76, s53
  s_lshl_b32 s53, s51, 7
  s_add_u32 s76, s76, s53
  s_add_u32 s76, s76, 0
  s_add_u32 s77, s76, 131072
  s_add_u32 s78, s76, 262144
  s_add_u32 s79, s76, 393216
  v_lshlrev_b32 v26, 4, v2
  v_mov_b32 v24, 0
  v_mov_b32 v25, 0
  s_mov_b32 s63, 0x3f803f80
  v_bfe_u32 v145, v0, 3, 2
  v_lshlrev_b32 v145, 17, v145
  v_bfe_u32 v146, v0, 2, 1
  v_lshl_add_u32 v145, v146, 19, v145
  v_and_b32 v146, 3, v0
  v_lshl_add_u32 v145, v146, 9, v145
  buffer_load_dword v147, v145, s[12:15], s76 offen
  s_and_b32 s80, s2, 7
  s_lshl_b32 s80, s80, 1
  s_lshr_b32 s81, s2, 7
  s_add_u32 s80, s80, s81
  s_lshl_b32 s80, s80, 4
  s_bfe_u32 s81, s2, 0x40003
  s_add_u32 s80, s80, s81
  s_lshl_b32 s80, s80, 7
  s_lshl_b32 s81, s2, 7
  s_add_u32 s81, s81, 8454144
  s_add_u32 s80, s80, 8552448
  v_mov_b32 v159, s81
  v_mov_b32 v158, s80
  v_cmp_eq_u32 vcc, 1, v0
  s_nop 1
  v_cndmask_b32 v159, v159, v158, vcc
  v_add_u32 v158, 32768, v158
  v_cmp_eq_u32 vcc, 2, v0
  s_nop 1
  v_cndmask_b32 v159, v159, v158, vcc
  buffer_load_dword v157, v159, s[12:15], 0 offen
  s_lshr_b32 s81, s2, 3
  s_and_b32 s81, s81, 15
  s_mov_b32 s72, s64
  s_and_b32 s73, s65, 0xffff
  s_mov_b32 s74, 1835008
  s_mov_b32 s75, 0x20000
  v_add_u32 v148, 0, v0
  v_mul_u32_u24 v150, 4682, v148
  v_lshrrev_b32 v150, 16, v150
  v_mad_i32_i24 v148, v150, -14, v148
  v_mul_u32_u24 v150, 3584, v150
  v_lshl_add_u32 v150, v148, 4, v150
  v_add_u32 v148, 64, v0
  v_mul_u32_u24 v151, 4682, v148
  v_lshrrev_b32 v151, 16, v151
  v_mad_i32_i24 v148, v151, -14, v148
  v_mul_u32_u24 v151, 3584, v151
  v_lshl_add_u32 v151, v148, 4, v151
  v_add_u32 v148, 128, v0
  v_mul_u32_u24 v152, 4682, v148
  v_lshrrev_b32 v152, 16, v152
  v_mad_i32_i24 v148, v152, -14, v148
  v_mul_u32_u24 v152, 3584, v152
  v_lshl_add_u32 v152, v148, 4, v152
  v_add_u32 v148, 192, v0
  v_mul_u32_u24 v153, 4682, v148
  v_lshrrev_b32 v153, 16, v153
  v_mad_i32_i24 v148, v153, -14, v148
  v_mul_u32_u24 v153, 3584, v153
  v_lshl_add_u32 v153, v148, 4, v153
  v_add_u32 v148, 256, v0
  v_mul_u32_u24 v154, 4682, v148
  v_lshrrev_b32 v154, 16, v154
  v_mad_i32_i24 v148, v154, -14, v148
  v_mul_u32_u24 v154, 3584, v154
  v_lshl_add_u32 v154, v148, 4, v154
  v_add_u32 v148, 320, v0
  v_mul_u32_u24 v155, 4682, v148
  v_lshrrev_b32 v155, 16, v155
  v_mad_i32_i24 v148, v155, -14, v148
  v_mul_u32_u24 v155, 3584, v155
  v_lshl_add_u32 v155, v148, 4, v155
  v_add_u32 v148, 384, v0
  v_mul_u32_u24 v156, 4682, v148
  v_lshrrev_b32 v156, 16, v156
  v_mad_i32_i24 v148, v156, -14, v148
  v_mul_u32_u24 v156, 3584, v156
  v_lshl_add_u32 v156, v148, 4, v156
  s_mul_i32 s70, s33, 458752
  s_mul_i32 s71, s81, 224
  s_add_u32 s70, s70, s71
  s_mul_i32 s71, s33, 28672
  s_add_u32 s71, s71, 49152
  s_mov_b32 m0, s71
  s_add_u32 s71, s71, 1024
  buffer_load_dwordx4 v150, s[72:75], s70 offen lds
  s_mov_b32 m0, s71
  s_add_u32 s71, s71, 1024
  buffer_load_dwordx4 v151, s[72:75], s70 offen lds
  s_mov_b32 m0, s71
  s_add_u32 s71, s71, 1024
  buffer_load_dwordx4 v152, s[72:75], s70 offen lds
  s_mov_b32 m0, s71
  s_add_u32 s71, s71, 1024
  buffer_load_dwordx4 v153, s[72:75], s70 offen lds
  s_waitcnt vmcnt(8)
  ds_read_b128 v[32:35], v15 offset:0
  ds_read_b128 v[36:39], v14 offset:0
  ds_read_b128 v[40:43], v15 offset:256
  ds_read_b128 v[44:47], v14 offset:256
  ds_read_b128 v[48:51], v15 offset:512
  ds_read_b128 v[52:55], v14 offset:512
  ds_read_b128 v[56:59], v15 offset:768
  ds_read_b128 v[60:63], v14 offset:768
  s_waitcnt lgkmcnt(7)
  v_dot2c_f32_bf16 v24, s63, v32
  v_dot2c_f32_bf16 v25, v32, v32
  v_dot2c_f32_bf16 v24, s63, v33
  v_dot2c_f32_bf16 v25, v33, v33
  v_dot2c_f32_bf16 v24, s63, v34
  v_dot2c_f32_bf16 v25, v34, v34
  v_dot2c_f32_bf16 v24, s63, v35
  v_dot2c_f32_bf16 v25, v35, v35
  s_waitcnt lgkmcnt(6)
  v_dot2c_f32_bf16 v24, s63, v36
  v_dot2c_f32_bf16 v25, v36, v36
  v_dot2c_f32_bf16 v24, s63, v37
  v_dot2c_f32_bf16 v25, v37, v37
  v_dot2c_f32_bf16 v24, s63, v38
  v_dot2c_f32_bf16 v25, v38, v38
  v_dot2c_f32_bf16 v24, s63, v39
  v_dot2c_f32_bf16 v25, v39, v39
  s_waitcnt lgkmcnt(5)
  v_dot2c_f32_bf16 v24, s63, v40
  v_dot2c_f32_bf16 v25, v40, v40
  v_dot2c_f32_bf16 v24, s63, v41
  v_dot2c_f32_bf16 v25, v41, v41
  v_dot2c_f32_bf16 v24, s63, v42
  v_dot2c_f32_bf16 v25, v42, v42
  v_dot2c_f32_bf16 v24, s63, v43
  v_dot2c_f32_bf16 v25, v43, v43
  s_waitcnt lgkmcnt(4)
  v_dot2c_f32_bf16 v24, s63, v44
  v_dot2c_f32_bf16 v25, v44, v44
  v_dot2c_f32_bf16 v24, s63, v45
  v_dot2c_f32_bf16 v25, v45, v45
  v_dot2c_f32_bf16 v24, s63, v46
  v_dot2c_f32_bf16 v25, v46, v46
  v_dot2c_f32_bf16 v24, s63, v47
  v_dot2c_f32_bf16 v25, v47, v47
  s_waitcnt lgkmcnt(3)
  v_dot2c_f32_bf16 v24, s63, v48
  v_dot2c_f32_bf16 v25, v48, v48
  v_dot2c_f32_bf16 v24, s63, v49
  v_dot2c_f32_bf16 v25, v49, v49
  v_dot2c_f32_bf16 v24, s63, v50
  v_dot2c_f32_bf16 v25, v50, v50
  v_dot2c_f32_bf16 v24, s63, v51
  v_dot2c_f32_bf16 v25, v51, v51
  s_waitcnt lgkmcnt(2)
  v_dot2c_f32_bf16 v24, s63, v52
  v_dot2c_f32_bf16 v25, v52, v52
  v_dot2c_f32_bf16 v24, s63, v53
  v_dot2c_f32_bf16 v25, v53, v53
  v_dot2c_f32_bf16 v24, s63, v54
  v_dot2c_f32_bf16 v25, v54, v54
  v_dot2c_f32_bf16 v24, s63, v55
  v_dot2c_f32_bf16 v25, v55, v55
  s_waitcnt lgkmcnt(1)
  v_dot2c_f32_bf16 v24, s63, v56
  v_dot2c_f32_bf16 v25, v56, v56
  v_dot2c_f32_bf16 v24, s63, v57
  v_dot2c_f32_bf16 v25, v57, v57
  v_dot2c_f32_bf16 v24, s63, v58
  v_dot2c_f32_bf16 v25, v58, v58
  v_dot2c_f32_bf16 v24, s63, v59
  v_dot2c_f32_bf16 v25, v59, v59
  s_waitcnt lgkmcnt(0)
  v_dot2c_f32_bf16 v24, s63, v60
  v_dot2c_f32_bf16 v25, v60, v60
  v_dot2c_f32_bf16 v24, s63, v61
  v_dot2c_f32_bf16 v25, v61, v61
  v_dot2c_f32_bf16 v24, s63, v62
  v_dot2c_f32_bf16 v25, v62, v62
  v_dot2c_f32_bf16 v24, s63, v63
  v_dot2c_f32_bf16 v25, v63, v63
  s_nop 1
  v_add_f32_dpp v24, v24, v24 quad_perm:[1,0,3,2] row_mask:0xf bank_mask:0xf
  v_add_f32_dpp v25, v25, v25 quad_perm:[1,0,3,2] row_mask:0xf bank_mask:0xf
  s_nop 0
  v_add_f32_dpp v24, v24, v24 quad_perm:[2,3,0,1] row_mask:0xf bank_mask:0xf
  v_add_f32_dpp v25, v25, v25 quad_perm:[2,3,0,1] row_mask:0xf bank_mask:0xf
  s_nop 0
  v_add_f32_dpp v24, v24, v24 row_half_mirror row_mask:0xf bank_mask:0xf
  v_add_f32_dpp v25, v25, v25 row_half_mirror row_mask:0xf bank_mask:0xf
  v_mul_f32 v24, 0x3b000000, v24
  v_mul_f32 v25, 0x3b000000, v25
  v_fma_f32 v25, -v24, v24, v25
  v_max_f32 v25, 0, v25
  v_add_f32 v25, 0x3727c5ac, v25
  v_rsq_f32 v25, v25
  v_sub_f32 v24, 0, v24
  ds_write_b32 v13, v25 offset:32768
  ds_write_b32 v13, v24 offset:32896
  s_waitcnt lgkmcnt(0)
  s_barrier
  ds_read_b128 v[32:35], v26 offset:32768
  ds_read_b128 v[36:39], v26 offset:32832
  ds_read_b128 v[40:43], v26 offset:32896
  ds_read_b128 v[44:47], v26 offset:32960
  ds_read_b64_tr_b16 v[80:81], v140 offset:0
  ds_read_b64_tr_b16 v[82:83], v140 offset:16384
  ds_read_b64_tr_b16 v[84:85], v140 offset:8
  ds_read_b64_tr_b16 v[86:87], v140 offset:16392
  ds_read_b64_tr_b16 v[88:89], v141 offset:0
  ds_read_b64_tr_b16 v[90:91], v141 offset:16384
  ds_read_b64_tr_b16 v[92:93], v141 offset:8
  ds_read_b64_tr_b16 v[94:95], v141 offset:16392
  s_waitcnt lgkmcnt(8)
  ds_read_b64_tr_b16 v[96:97], v142 offset:0
  ds_read_b64_tr_b16 v[98:99], v142 offset:16384
  ds_read_b64_tr_b16 v[100:101], v142 offset:8
  ds_read_b64_tr_b16 v[102:103], v142 offset:16392
  ds_read_b64_tr_b16 v[104:105], v143 offset:0
  ds_read_b64_tr_b16 v[106:107], v143 offset:16384
  ds_read_b64_tr_b16 v[108:109], v143 offset:8
  ds_read_b64_tr_b16 v[110:111], v143 offset:16392
  s_waitcnt vmcnt(6)
  v_pk_mul_f32 v[16:17], v[16:17], v[32:33]
  v_pk_mul_f32 v[18:19], v[18:19], v[34:35]
  v_pk_mul_f32 v[20:21], v[20:21], v[36:37]
  v_pk_mul_f32 v[22:23], v[22:23], v[38:39]
  v_cvt_pk_bf16_f32 v48, v16, v17
  v_cvt_pk_bf16_f32 v49, v18, v19
  v_cvt_pk_bf16_f32 v50, v20, v21
  v_cvt_pk_bf16_f32 v51, v22, v23
  v_cvt_pk_bf16_f32 v52, v40, v41
  v_cvt_pk_bf16_f32 v53, v42, v43
  v_cvt_pk_bf16_f32 v54, v44, v45
  v_cvt_pk_bf16_f32 v55, v46, v47
  s_nop 1
  v_mfma_f32_16x16x32_bf16 v[60:63], v[48:51], v[52:55], 0
  v_lshlrev_b32 v16, 16, v52
  v_and_b32 v17, 0xffff0000, v52
  v_lshlrev_b32 v18, 16, v53
  v_and_b32 v19, 0xffff0000, v53
  v_lshlrev_b32 v20, 16, v54
  v_and_b32 v21, 0xffff0000, v54
  v_lshlrev_b32 v22, 16, v55
  v_and_b32 v23, 0xffff0000, v55
  v_pk_add_f32 v[16:17], v[40:41], v[16:17] neg_lo:[0,1] neg_hi:[0,1]
  v_pk_add_f32 v[18:19], v[42:43], v[18:19] neg_lo:[0,1] neg_hi:[0,1]
  v_pk_add_f32 v[20:21], v[44:45], v[20:21] neg_lo:[0,1] neg_hi:[0,1]
  v_pk_add_f32 v[22:23], v[46:47], v[22:23] neg_lo:[0,1] neg_hi:[0,1]
  v_cvt_pk_bf16_f32 v56, v16, v17
  v_cvt_pk_bf16_f32 v57, v18, v19
  v_cvt_pk_bf16_f32 v58, v20, v21
  v_cvt_pk_bf16_f32 v59, v22, v23
  s_nop 1
  v_mfma_f32_16x16x32_bf16 v[60:63], v[48:51], v[56:59], v[60:63]
  s_waitcnt lgkmcnt(14)
  v_mfma_f32_16x16x32_bf16 v[112:115], v[48:51], v[80:83], v[60:63]
  s_waitcnt lgkmcnt(12)
  v_mfma_f32_16x16x32_bf16 v[116:119], v[48:51], v[84:87], v[60:63]
  s_waitcnt lgkmcnt(10)
  v_mfma_f32_16x16x32_bf16 v[120:123], v[48:51], v[88:91], v[60:63]
  s_waitcnt lgkmcnt(8)
  v_mfma_f32_16x16x32_bf16 v[124:127], v[48:51], v[92:95], v[60:63]
  s_waitcnt lgkmcnt(6)
  v_mfma_f32_16x16x32_bf16 v[128:131], v[48:51], v[96:99], v[60:63]
  s_waitcnt lgkmcnt(4)
  v_mfma_f32_16x16x32_bf16 v[132:135], v[48:51], v[100:103], v[60:63]
  s_waitcnt lgkmcnt(2)
  v_mfma_f32_16x16x32_bf16 v[136:139], v[48:51], v[104:107], v[60:63]
  s_waitcnt lgkmcnt(0)
  v_mfma_f32_16x16x32_bf16 v[140:143], v[48:51], v[108:111], v[60:63]
  v_cvt_pk_bf16_f32 v32, v112, v113
  v_cvt_pk_bf16_f32 v33, v116, v117
  v_cvt_pk_bf16_f32 v34, v120, v121
  v_cvt_pk_bf16_f32 v35, v124, v125
  v_cvt_pk_bf16_f32 v36, v128, v129
  v_cvt_pk_bf16_f32 v37, v132, v133
  v_cvt_pk_bf16_f32 v38, v136, v137
  s_nop 0
  v_cvt_pk_bf16_f32 v39, v140, v141
  v_permlane16_swap_b32 v32, v36
  v_permlane16_swap_b32 v33, v37
  v_permlane16_swap_b32 v34, v38
  v_permlane16_swap_b32 v35, v39
  buffer_store_dwordx4 v[32:35], v144, s[12:15], s76 offen sc1
  buffer_store_dwordx4 v[36:39], v144, s[12:15], s78 offen sc1
  v_cvt_pk_bf16_f32 v40, v114, v115
  v_cvt_pk_bf16_f32 v41, v118, v119
  v_cvt_pk_bf16_f32 v42, v122, v123
  v_cvt_pk_bf16_f32 v43, v126, v127
  v_cvt_pk_bf16_f32 v44, v130, v131
  v_cvt_pk_bf16_f32 v45, v134, v135
  v_cvt_pk_bf16_f32 v46, v138, v139
  v_cvt_pk_bf16_f32 v47, v142, v143
  v_permlane16_swap_b32 v40, v44
  v_permlane16_swap_b32 v41, v45
  v_permlane16_swap_b32 v42, v46
  v_permlane16_swap_b32 v43, v47
  buffer_store_dwordx4 v[40:43], v144, s[12:15], s77 offen sc1
  buffer_store_dwordx4 v[44:47], v144, s[12:15], s79 offen sc1
  s_branch adaLN_cond__spectral_fnet__dense_activation_relu__prompt_kernel_adone
adaLN_cond__spectral_fnet__dense_activation_relu__prompt_kernel_notA:
  s_mov_b32 s12, s38
  s_and_b32 s13, s39, 0xffff
  s_mov_b32 s14, 19922944
  s_mov_b32 s15, 0x20000
  s_add_u32 s98, s38, 8491008
  s_addc_u32 s99, s39, 0
  s_load_dword s100, s[98:99], 0
  s_mov_b32 s16, s40
  s_and_b32 s17, s41, 0xffff
  s_mov_b32 s18, 1835008
  s_mov_b32 s19, 0x20000
  s_mov_b32 s28, s44
  s_and_b32 s29, s45, 0xffff
  s_mov_b32 s30, 1024
  s_mov_b32 s31, 0x20000
  s_mov_b32 s24, s46
  s_and_b32 s25, s47, 0xffff
  s_mov_b32 s26, 3145728
  s_mov_b32 s27, 0x20000
  s_sub_u32 s35, s2, 128
  s_lshl_b32 s54, s35, 2
  s_add_u32 s54, s54, s33
  s_cmp_ge_u32 s2, 224
  s_cbranch_scc1 adaLN_cond__spectral_fnet__dense_activation_relu__prompt_kernel_oldw2
  s_lshr_b32 s34, s35, 4
  s_lshl_b32 s34, s34, 4
  s_and_b32 s48, s35, 7
  s_lshl_b32 s48, s48, 1
  s_add_u32 s34, s34, s48
  s_bfe_u32 s48, s35, 0x10003
  s_add_u32 s34, s34, s48
  v_lshrrev_b32 v4, 2, v0
  v_mul_u32_u24 v4, 6144, v4
  v_and_b32 v5, 3, v0
  v_lshl_add_u32 v4, v5, 4, v4
  s_mul_i32 s48, s33, 786432
  s_lshl_b32 s49, s34, 6
  s_add_u32 s48, s48, s49
  s_lshl_b32 s49, s33, 13
  v_lshlrev_b32 v6, 2, v0
  s_lshl_b32 s50, s33, 8
  buffer_load_dword v7, v6, s[28:31], s50 offen
  s_mov_b32 m0, s49
  s_add_u32 s49, s49, 1024
  buffer_load_dwordx4 v4, s[24:27], s48 offen lds
  s_mov_b32 m0, s49
  s_add_u32 s48, s48, 98304
  s_add_u32 s49, s49, 1024
  buffer_load_dwordx4 v4, s[24:27], s48 offen lds
  s_mov_b32 m0, s49
  s_add_u32 s48, s48, 98304
  s_add_u32 s49, s49, 1024
  buffer_load_dwordx4 v4, s[24:27], s48 offen lds
  s_mov_b32 m0, s49
  s_add_u32 s48, s48, 98304
  s_add_u32 s49, s49, 1024
  buffer_load_dwordx4 v4, s[24:27], s48 offen lds
  s_mov_b32 m0, s49
  s_add_u32 s48, s48, 98304
  s_add_u32 s49, s49, 1024
  buffer_load_dwordx4 v4, s[24:27], s48 offen lds
  s_mov_b32 m0, s49
  s_add_u32 s48, s48, 98304
  s_add_u32 s49, s49, 1024
  buffer_load_dwordx4 v4, s[24:27], s48 offen lds
  s_mov_b32 m0, s49
  s_add_u32 s48, s48, 98304
  s_add_u32 s49, s49, 1024
  buffer_load_dwordx4 v4, s[24:27], s48 offen lds
  s_mov_b32 m0, s49
  s_add_u32 s48, s48, 98304
  s_add_u32 s49, s49, 1024
  buffer_load_dwordx4 v4, s[24:27], s48 offen lds
  s_mul_i32 s55, s54, 1171
  s_lshr_b32 s55, s55, 16
  s_mul_i32 s56, s55, 56
  s_sub_u32 s56, s54, s56
  s_mul_i32 s57, s56, 4682
  s_lshr_b32 s57, s57, 16
  s_mul_i32 s58, s57, 14
  s_sub_u32 s58, s56, s58
  s_mul_i32 s59, s57, 448
  s_mul_i32 s60, s58, 21846
  s_lshr_b32 s60, s60, 16
  s_mul_i32 s61, s60, 3
  s_sub_u32 s61, s58, s61
  s_mul_i32 s60, s60, 112
  s_lshl_b32 s61, s61, 5
  s_add_u32 s60, s60, s61
  v_lshlrev_b32 v9, 2, v2
  v_add_u32 v9, s60, v9
  s_sub_u32 s61, s58, 12
  s_lshl_b32 s61, s61, 1
  v_lshrrev_b32 v10, 1, v2
  v_add_u32 v10, s61, v10
  v_mul_u32_u24 v10, 112, v10
  v_and_b32 v11, 1, v2
  v_lshlrev_b32 v11, 3, v11
  v_add3_u32 v10, v10, v11, 64
  v_add_u32 v10, 32, v10
  s_cmp_ge_u32 s58, 12
  s_cselect_b64 vcc, -1, 0
  s_movk_i32 s61, 0x4000
  s_cselect_b32 s61, 4096, s61
  v_cndmask_b32 v9, v9, v10, vcc
  v_add_u32 v9, s59, v9
  v_lshlrev_b32 v9, 10, v9
  v_lshlrev_b32 v10, 3, v3
  v_add_u32 v9, v9, v10
  v_add_u32 v10, s61, v9
  s_lshl_b32 s62, s55, 7
  buffer_load_dwordx2 v[64:65], v9, s[16:19], s62 offen offset:0
  buffer_load_dwordx2 v[66:67], v9, s[16:19], s62 offen offset:1024
  buffer_load_dwordx2 v[68:69], v9, s[16:19], s62 offen offset:2048
  buffer_load_dwordx2 v[70:71], v9, s[16:19], s62 offen offset:3072
  buffer_load_dwordx2 v[72:73], v10, s[16:19], s62 offen offset:0
  buffer_load_dwordx2 v[74:75], v10, s[16:19], s62 offen offset:1024
  buffer_load_dwordx2 v[76:77], v10, s[16:19], s62 offen offset:2048
  buffer_load_dwordx2 v[78:79], v10, s[16:19], s62 offen offset:3072
  s_and_b32 s80, s2, 7
  s_lshl_b32 s80, s80, 1
  s_lshr_b32 s81, s2, 7
  s_add_u32 s80, s80, s81
  s_lshl_b32 s80, s80, 4
  s_bfe_u32 s81, s2, 0x40003
  s_add_u32 s80, s80, s81
  s_lshl_b32 s80, s80, 7
  s_lshl_b32 s81, s2, 7
  s_add_u32 s81, s81, 8454144
  s_add_u32 s80, s80, 8552448
  v_mov_b32 v159, s81
  v_mov_b32 v158, s80
  v_cmp_eq_u32 vcc, 1, v0
  s_nop 1
  v_cndmask_b32 v159, v159, v158, vcc
  v_add_u32 v158, 32768, v158
  v_cmp_eq_u32 vcc, 2, v0
  s_nop 1
  v_cndmask_b32 v159, v159, v158, vcc
  buffer_load_dword v157, v159, s[12:15], 0 offen
  s_lshr_b32 s81, s2, 3
  s_and_b32 s81, s81, 15
  s_mov_b32 s72, s64
  s_and_b32 s73, s65, 0xffff
  s_mov_b32 s74, 1835008
  s_mov_b32 s75, 0x20000
  v_add_u32 v148, 0, v0
  v_mul_u32_u24 v150, 4682, v148
  v_lshrrev_b32 v150, 16, v150
  v_mad_i32_i24 v148, v150, -14, v148
  v_mul_u32_u24 v150, 3584, v150
  v_lshl_add_u32 v150, v148, 4, v150
  v_add_u32 v148, 64, v0
  v_mul_u32_u24 v151, 4682, v148
  v_lshrrev_b32 v151, 16, v151
  v_mad_i32_i24 v148, v151, -14, v148
  v_mul_u32_u24 v151, 3584, v151
  v_lshl_add_u32 v151, v148, 4, v151
  v_add_u32 v148, 128, v0
  v_mul_u32_u24 v152, 4682, v148
  v_lshrrev_b32 v152, 16, v152
  v_mad_i32_i24 v148, v152, -14, v148
  v_mul_u32_u24 v152, 3584, v152
  v_lshl_add_u32 v152, v148, 4, v152
  v_add_u32 v148, 192, v0
  v_mul_u32_u24 v153, 4682, v148
  v_lshrrev_b32 v153, 16, v153
  v_mad_i32_i24 v148, v153, -14, v148
  v_mul_u32_u24 v153, 3584, v153
  v_lshl_add_u32 v153, v148, 4, v153
  v_add_u32 v148, 256, v0
  v_mul_u32_u24 v154, 4682, v148
  v_lshrrev_b32 v154, 16, v154
  v_mad_i32_i24 v148, v154, -14, v148
  v_mul_u32_u24 v154, 3584, v154
  v_lshl_add_u32 v154, v148, 4, v154
  v_add_u32 v148, 320, v0
  v_mul_u32_u24 v155, 4682, v148
  v_lshrrev_b32 v155, 16, v155
  v_mad_i32_i24 v148, v155, -14, v148
  v_mul_u32_u24 v155, 3584, v155
  v_lshl_add_u32 v155, v148, 4, v155
  v_add_u32 v148, 384, v0
  v_mul_u32_u24 v156, 4682, v148
  v_lshrrev_b32 v156, 16, v156
  v_mad_i32_i24 v148, v156, -14, v148
  v_mul_u32_u24 v156, 3584, v156
  v_lshl_add_u32 v156, v148, 4, v156
  s_mul_i32 s70, s33, 458752
  s_mul_i32 s71, s81, 224
  s_add_u32 s70, s70, s71
  s_mul_i32 s71, s33, 28672
  s_add_u32 s71, s71, 49152
  s_mov_b32 m0, s71
  s_add_u32 s71, s71, 1024
  buffer_load_dwordx4 v150, s[72:75], s70 offen lds
  s_mov_b32 m0, s71
  s_add_u32 s71, s71, 1024
  buffer_load_dwordx4 v151, s[72:75], s70 offen lds
  s_mov_b32 m0, s71
  s_add_u32 s71, s71, 1024
  buffer_load_dwordx4 v152, s[72:75], s70 offen lds
  s_mov_b32 m0, s71
  s_add_u32 s71, s71, 1024
  buffer_load_dwordx4 v153, s[72:75], s70 offen lds
  s_waitcnt vmcnt(21)
adaLN_cond__spectral_fnet__dense_activation_relu__prompt_kernel_modgo:
  v_lshlrev_b32 v12, 16, v7
  v_and_b32 v13, 0xffff0000, v7
  v_mul_f32 v14, 0xbfb8aa3b, v12
  v_exp_f32 v14, v14
  s_nop 0
  v_add_f32 v14, 1.0, v14
  v_rcp_f32 v14, v14
  s_nop 0
  v_mul_f32 v12, v12, v14
  v_mul_f32 v15, 0xbfb8aa3b, v13
  v_exp_f32 v15, v15
  s_nop 0
  v_add_f32 v15, 1.0, v15
  v_rcp_f32 v15, v15
  s_nop 0
  v_mul_f32 v13, v13, v15
  v_cvt_pk_bf16_f32 v12, v12, v13
  v_add_u32 v6, s50, v6
  ds_write_b32 v6, v12 offset:32768
  s_waitcnt lgkmcnt(0)
  v_lshlrev_b32 v12, 3, v2
  v_add_u32 v12, s50, v12
  ds_read_b64 v[16:17], v12 offset:32768
  ds_read_b64 v[18:19], v12 offset:32800
  ds_read_b64 v[20:21], v12 offset:32832
  ds_read_b64 v[22:23], v12 offset:32864
  ds_read_b64 v[24:25], v12 offset:32896
  ds_read_b64 v[26:27], v12 offset:32928
  ds_read_b64 v[28:29], v12 offset:32960
  ds_read_b64 v[30:31], v12 offset:32992
  v_lshrrev_b32 v14, 2, v3
  v_lshl_add_u32 v14, v2, 2, v14
  v_lshlrev_b32 v14, 6, v14
  v_and_b32 v15, 3, v3
  v_lshl_add_u32 v14, v15, 3, v14
  s_lshl_b32 s51, s33, 13
  v_add_u32 v14, s51, v14
  s_waitcnt lgkmcnt(0) vmcnt(13)
  ds_read_b64_tr_b16 v[32:33], v14 offset:0
  ds_read_b64_tr_b16 v[34:35], v14 offset:1024
  ds_read_b64_tr_b16 v[36:37], v14 offset:32
  ds_read_b64_tr_b16 v[38:39], v14 offset:1056
  ds_read_b64_tr_b16 v[40:41], v14 offset:2048
  ds_read_b64_tr_b16 v[42:43], v14 offset:3072
  ds_read_b64_tr_b16 v[44:45], v14 offset:2080
  ds_read_b64_tr_b16 v[46:47], v14 offset:3104
  ds_read_b64_tr_b16 v[48:49], v14 offset:4096
  ds_read_b64_tr_b16 v[50:51], v14 offset:5120
  ds_read_b64_tr_b16 v[52:53], v14 offset:4128
  ds_read_b64_tr_b16 v[54:55], v14 offset:5152
  s_waitcnt lgkmcnt(4)
  ds_read_b64_tr_b16 v[56:57], v14 offset:6144
  ds_read_b64_tr_b16 v[58:59], v14 offset:7168
  ds_read_b64_tr_b16 v[60:61], v14 offset:6176
  ds_read_b64_tr_b16 v[62:63], v14 offset:7200
  s_waitcnt lgkmcnt(0)
  v_mfma_f32_16x16x32_bf16 v[100:103], v[16:19], v[32:35], 0
  v_mfma_f32_16x16x32_bf16 v[104:107], v[16:19], v[36:39], 0
  v_mfma_f32_16x16x32_bf16 v[100:103], v[20:23], v[40:43], v[100:103]
  v_mfma_f32_16x16x32_bf16 v[104:107], v[20:23], v[44:47], v[104:107]
  v_mfma_f32_16x16x32_bf16 v[100:103], v[24:27], v[48:51], v[100:103]
  v_mfma_f32_16x16x32_bf16 v[104:107], v[24:27], v[52:55], v[104:107]
  v_mfma_f32_16x16x32_bf16 v[100:103], v[28:31], v[56:59], v[100:103]
  v_mfma_f32_16x16x32_bf16 v[104:107], v[28:31], v[60:63], v[104:107]
  v_lshlrev_b32 v15, 2, v3
  s_lshl_b32 s51, s33, 7
  v_add_u32 v15, s51, v15
  s_nop 3
  ds_write_b32 v15, v100 offset:33792
  ds_write_b32 v15, v104 offset:33856
  s_waitcnt lgkmcnt(0)
  s_barrier
  s_cmp_lg_u32 s33, 0
  s_cbranch_scc1 adaLN_cond__spectral_fnet__dense_activation_relu__prompt_kernel_o2st
  v_and_b32 v12, 31, v0
  v_lshlrev_b32 v13, 2, v12
  ds_read_b32 v16, v13 offset:33792
  ds_read_b32 v17, v13 offset:33920
  ds_read_b32 v18, v13 offset:34048
  ds_read_b32 v19, v13 offset:34176
  s_waitcnt lgkmcnt(0)
  v_add_f32 v16, v16, v17
  v_add_f32 v18, v18, v19
  v_add_f32 v16, v16, v18
  v_cvt_pk_bf16_f32 v16, v16, v16
  v_and_b32 v16, 0xffff0000, v16
  s_lshr_b32 s35, s34, 4
  v_add_f32 v17, 1.0, v16
  v_cvt_pk_bf16_f32 v17, v17, v17
  v_and_b32 v17, 0xffff0000, v17
  s_cmp_eq_u32 s35, 1
  s_cselect_b32 s50, 1, 0
  s_cmp_eq_u32 s35, 4
  s_cselect_b32 s50, 1, s50
  s_cmp_eq_u32 s50, 1
  s_cselect_b64 vcc, -1, 0
  v_cndmask_b32 v16, v16, v17, vcc
  s_lshl_b32 s50, s34, 7
  s_add_u32 s50, s50, 8388608
  s_mov_b32 exec_hi, 0
  buffer_store_dword v16, v13, s[12:15], s50 offen sc1
  s_mov_b64 exec, -1
  s_waitcnt vmcnt(6)
  s_branch adaLN_cond__spectral_fnet__dense_activation_relu__prompt_kernel_o2go
adaLN_cond__spectral_fnet__dense_activation_relu__prompt_kernel_o2st:
  s_waitcnt vmcnt(5)
adaLN_cond__spectral_fnet__dense_activation_relu__prompt_kernel_o2go:
  s_mov_b32 s60, 0x05040100
  s_mov_b32 s61, 0x07060302
  v_perm_b32 v80, v66, v64, s60
  v_perm_b32 v81, v70, v68, s60
  v_perm_b32 v82, v74, v72, s60
  v_perm_b32 v83, v78, v76, s60
  v_perm_b32 v84, v66, v64, s61
  v_perm_b32 v85, v70, v68, s61
  v_perm_b32 v86, v74, v72, s61
  v_perm_b32 v87, v78, v76, s61
  v_perm_b32 v88, v67, v65, s60
  v_perm_b32 v89, v71, v69, s60
  v_perm_b32 v90, v75, v73, s60
  v_perm_b32 v91, v79, v77, s60
  v_perm_b32 v92, v67, v65, s61
  v_perm_b32 v93, v71, v69, s61
  v_perm_b32 v94, v75, v73, s61
  v_perm_b32 v95, v79, v77, s61
  s_lshl_b32 s63, s54, 12
  s_add_u32 s63, s63, 6291456
  v_lshlrev_b32 v8, 4, v0
  buffer_store_dwordx4 v[80:83], v8, s[12:15], s63 offen offset:0 sc1
  buffer_store_dwordx4 v[84:87], v8, s[12:15], s63 offen offset:1024 sc1
  buffer_store_dwordx4 v[88:91], v8, s[12:15], s63 offen offset:2048 sc1
  buffer_store_dwordx4 v[92:95], v8, s[12:15], s63 offen offset:3072 sc1
  s_branch adaLN_cond__spectral_fnet__dense_activation_relu__prompt_kernel_adone
adaLN_cond__spectral_fnet__dense_activation_relu__prompt_kernel_oldw2:
  s_and_b32 s80, s2, 7
  s_lshl_b32 s80, s80, 1
  s_lshr_b32 s81, s2, 7
  s_add_u32 s80, s80, s81
  s_lshl_b32 s80, s80, 4
  s_bfe_u32 s81, s2, 0x40003
  s_add_u32 s80, s80, s81
  s_lshl_b32 s80, s80, 7
  s_lshl_b32 s81, s2, 7
  s_add_u32 s81, s81, 8454144
  s_add_u32 s80, s80, 8552448
  v_mov_b32 v159, s81
  v_mov_b32 v158, s80
  v_cmp_eq_u32 vcc, 1, v0
  s_nop 1
  v_cndmask_b32 v159, v159, v158, vcc
  v_add_u32 v158, 32768, v158
  v_cmp_eq_u32 vcc, 2, v0
  s_nop 1
  v_cndmask_b32 v159, v159, v158, vcc
  buffer_load_dword v157, v159, s[12:15], 0 offen
  s_lshr_b32 s81, s2, 3
  s_and_b32 s81, s81, 15
  s_mov_b32 s72, s64
  s_and_b32 s73, s65, 0xffff
  s_mov_b32 s74, 1835008
  s_mov_b32 s75, 0x20000
  v_add_u32 v148, 0, v0
  v_mul_u32_u24 v150, 4682, v148
  v_lshrrev_b32 v150, 16, v150
  v_mad_i32_i24 v148, v150, -14, v148
  v_mul_u32_u24 v150, 3584, v150
  v_lshl_add_u32 v150, v148, 4, v150
  v_add_u32 v148, 64, v0
  v_mul_u32_u24 v151, 4682, v148
  v_lshrrev_b32 v151, 16, v151
  v_mad_i32_i24 v148, v151, -14, v148
  v_mul_u32_u24 v151, 3584, v151
  v_lshl_add_u32 v151, v148, 4, v151
  v_add_u32 v148, 128, v0
  v_mul_u32_u24 v152, 4682, v148
  v_lshrrev_b32 v152, 16, v152
  v_mad_i32_i24 v148, v152, -14, v148
  v_mul_u32_u24 v152, 3584, v152
  v_lshl_add_u32 v152, v148, 4, v152
  v_add_u32 v148, 192, v0
  v_mul_u32_u24 v153, 4682, v148
  v_lshrrev_b32 v153, 16, v153
  v_mad_i32_i24 v148, v153, -14, v148
  v_mul_u32_u24 v153, 3584, v153
  v_lshl_add_u32 v153, v148, 4, v153
  v_add_u32 v148, 256, v0
  v_mul_u32_u24 v154, 4682, v148
  v_lshrrev_b32 v154, 16, v154
  v_mad_i32_i24 v148, v154, -14, v148
  v_mul_u32_u24 v154, 3584, v154
  v_lshl_add_u32 v154, v148, 4, v154
  v_add_u32 v148, 320, v0
  v_mul_u32_u24 v155, 4682, v148
  v_lshrrev_b32 v155, 16, v155
  v_mad_i32_i24 v148, v155, -14, v148
  v_mul_u32_u24 v155, 3584, v155
  v_lshl_add_u32 v155, v148, 4, v155
  v_add_u32 v148, 384, v0
  v_mul_u32_u24 v156, 4682, v148
  v_lshrrev_b32 v156, 16, v156
  v_mad_i32_i24 v148, v156, -14, v148
  v_mul_u32_u24 v156, 3584, v156
  v_lshl_add_u32 v156, v148, 4, v156
  s_mul_i32 s70, s33, 458752
  s_mul_i32 s71, s81, 224
  s_add_u32 s70, s70, s71
  s_mul_i32 s71, s33, 28672
  s_add_u32 s71, s71, 49152
  s_mov_b32 m0, s71
  s_add_u32 s71, s71, 1024
  buffer_load_dwordx4 v150, s[72:75], s70 offen lds
  s_mov_b32 m0, s71
  s_add_u32 s71, s71, 1024
  buffer_load_dwordx4 v151, s[72:75], s70 offen lds
  s_mov_b32 m0, s71
  s_add_u32 s71, s71, 1024
  buffer_load_dwordx4 v152, s[72:75], s70 offen lds
  s_mov_b32 m0, s71
  s_add_u32 s71, s71, 1024
  buffer_load_dwordx4 v153, s[72:75], s70 offen lds
  s_getpc_b64 s[76:77]
adaLN_cond__spectral_fnet__dense_activation_relu__prompt_kernel_pcc:
  s_sub_u32 s76, s76, adaLN_cond__spectral_fnet__dense_activation_relu__prompt_kernel_pcc-adaLN_cond__spectral_fnet__dense_activation_relu__prompt_kernel
  s_subb_u32 s77, s77, 0
  s_and_b32 s77, s77, 0xffff
  s_mov_b32 s78, fnet_tables_end-adaLN_cond__spectral_fnet__dense_activation_relu__prompt_kernel
  s_mov_b32 s79, 0x20000
  v_lshlrev_b32 v142, 7, v0
  s_sub_u32 s80, s2, 224
  s_lshr_b32 s80, s80, 3
  s_lshl_b32 s80, s80, 2
  s_add_u32 s80, s80, s33
  s_lshl_b32 s80, s80, 13
  buffer_load_dword v141, v142, s[76:79], s80 offen
  s_sub_u32 s80, s2, 224
  s_lshr_b32 s80, s80, 3
  s_lshl_b32 s80, s80, 2
  s_add_u32 s80, s80, s33
  v_lshlrev_b32 v140, 16, v0
  s_lshl_b32 s81, s80, 22
  buffer_load_dword v139, v140, s[12:15], s81 offen
  s_load_dwordx2 s[76:77], s[0:1], 80
  s_waitcnt lgkmcnt(0)
  s_cmp_eq_u32 s80, 6
  s_cselect_b32 s76, s64, s76
  s_cselect_b32 s77, s65, s77
  s_mov_b32 s78, 1835008
  s_cselect_b32 s78, s78, 2097152
  s_and_b32 s77, s77, 0xffff
  s_mov_b32 s79, 0x20000
  s_sub_u32 s81, s80, 5
  s_cmp_lt_u32 s81, 2
  s_cselect_b32 s81, 0, 0x7fff0000
  buffer_load_dword v138, v140, s[76:79], s81 offen
  s_cmp_ge_u32 s54, 448
  s_cbranch_scc1 adaLN_cond__spectral_fnet__dense_activation_relu__prompt_kernel_adone
  s_mul_i32 s55, s54, 1171
  s_lshr_b32 s55, s55, 16
  s_mul_i32 s56, s55, 56
  s_sub_u32 s56, s54, s56
  s_mul_i32 s57, s56, 4682
  s_lshr_b32 s57, s57, 16
  s_mul_i32 s58, s57, 14
  s_sub_u32 s58, s56, s58
  s_mul_i32 s59, s57, 448
  s_mul_i32 s60, s58, 21846
  s_lshr_b32 s60, s60, 16
  s_mul_i32 s61, s60, 3
  s_sub_u32 s61, s58, s61
  s_mul_i32 s60, s60, 112
  s_lshl_b32 s61, s61, 5
  s_add_u32 s60, s60, s61
  v_lshlrev_b32 v9, 2, v2
  v_add_u32 v9, s60, v9
  s_sub_u32 s61, s58, 12
  s_lshl_b32 s61, s61, 1
  v_lshrrev_b32 v10, 1, v2
  v_add_u32 v10, s61, v10
  v_mul_u32_u24 v10, 112, v10
  v_and_b32 v11, 1, v2
  v_lshlrev_b32 v11, 3, v11
  v_add3_u32 v10, v10, v11, 64
  v_add_u32 v10, 32, v10
  s_cmp_ge_u32 s58, 12
  s_cselect_b64 vcc, -1, 0
  s_movk_i32 s61, 0x4000
  s_cselect_b32 s61, 4096, s61
  v_cndmask_b32 v9, v9, v10, vcc
  v_add_u32 v9, s59, v9
  v_lshlrev_b32 v9, 10, v9
  v_lshlrev_b32 v10, 3, v3
  v_add_u32 v9, v9, v10
  v_add_u32 v10, s61, v9
  s_lshl_b32 s62, s55, 7
  buffer_load_dwordx2 v[64:65], v9, s[16:19], s62 offen offset:0
  buffer_load_dwordx2 v[66:67], v9, s[16:19], s62 offen offset:1024
  buffer_load_dwordx2 v[68:69], v9, s[16:19], s62 offen offset:2048
  buffer_load_dwordx2 v[70:71], v9, s[16:19], s62 offen offset:3072
  buffer_load_dwordx2 v[72:73], v10, s[16:19], s62 offen offset:0
  buffer_load_dwordx2 v[74:75], v10, s[16:19], s62 offen offset:1024
  buffer_load_dwordx2 v[76:77], v10, s[16:19], s62 offen offset:2048
  buffer_load_dwordx2 v[78:79], v10, s[16:19], s62 offen offset:3072
  s_waitcnt vmcnt(0)
  s_mov_b32 s60, 0x05040100
  s_mov_b32 s61, 0x07060302
  v_perm_b32 v80, v66, v64, s60
  v_perm_b32 v81, v70, v68, s60
  v_perm_b32 v82, v74, v72, s60
  v_perm_b32 v83, v78, v76, s60
  v_perm_b32 v84, v66, v64, s61
  v_perm_b32 v85, v70, v68, s61
  v_perm_b32 v86, v74, v72, s61
  v_perm_b32 v87, v78, v76, s61
  v_perm_b32 v88, v67, v65, s60
  v_perm_b32 v89, v71, v69, s60
  v_perm_b32 v90, v75, v73, s60
  v_perm_b32 v91, v79, v77, s60
  v_perm_b32 v92, v67, v65, s61
  v_perm_b32 v93, v71, v69, s61
  v_perm_b32 v94, v75, v73, s61
  v_perm_b32 v95, v79, v77, s61
  s_lshl_b32 s63, s54, 12
  s_add_u32 s63, s63, 6291456
  v_lshlrev_b32 v8, 4, v0
  buffer_store_dwordx4 v[80:83], v8, s[12:15], s63 offen offset:0 sc1
  buffer_store_dwordx4 v[84:87], v8, s[12:15], s63 offen offset:1024 sc1
  buffer_store_dwordx4 v[88:91], v8, s[12:15], s63 offen offset:2048 sc1
  buffer_store_dwordx4 v[92:95], v8, s[12:15], s63 offen offset:3072 sc1
adaLN_cond__spectral_fnet__dense_activation_relu__prompt_kernel_adone:
  s_waitcnt lgkmcnt(0)
  s_mul_i32 s101, s100, 2654435761
  s_add_u32 s101, s101, 2246822507
  s_getreg_b32 s82, hwreg(HW_REG_XCC_ID)
  s_and_b32 s82, s82, 15
  s_add_u32 s82, s82, 1
  s_xor_b32 s60, s101, s82
  v_mov_b32 v5, s60
  s_lshl_b32 s60, s2, 7
  s_add_u32 s60, s60, 8454144
  v_mov_b32 v6, 0
  s_cmp_ge_u32 s2, 128
  s_mov_b32 s59, 0
  s_waitcnt vmcnt(0)
  s_barrier
  s_cmp_lg_u32 s33, 0
  s_cbranch_scc1 adaLN_cond__spectral_fnet__dense_activation_relu__prompt_kernel_anf
  s_add_u32 s60, s60, s59
  s_mov_b64 exec, 1
  buffer_store_dword v5, v6, s[12:15], s60 offen sc1
  s_mov_b64 exec, -1
adaLN_cond__spectral_fnet__dense_activation_relu__prompt_kernel_anf:
  s_and_b32 s81, s2, 7
  s_lshr_b32 s83, s2, 3
  s_lshr_b32 s80, s83, 4
  s_lshl_b32 s81, s81, 1
  s_add_u32 s81, s81, s80
  s_and_b32 s83, s83, 15
  v_lshlrev_b32 v147, 7, v0
  s_mul_i32 s80, s81, 458752
  s_mul_i32 s79, s83, 21504
  s_add_u32 s80, s80, s79
  s_lshl_b32 s79, s33, 13
  s_add_u32 s80, s80, s79
  s_add_u32 s80, s80, 10600448
  s_lshl_b32 s79, s81, 17
  s_lshr_b32 s78, s83, 1
  s_lshl_b32 s78, s78, 14
  s_add_u32 s79, s79, s78
  s_and_b32 s78, s83, 1
  s_lshl_b32 s78, s78, 7
  s_add_u32 s79, s79, s78
  s_add_u32 s79, s79, 2097152
  s_cmp_ge_u32 s33, 3
  s_cselect_b32 s80, s79, s80
  s_cselect_b32 s79, 8, 7
  s_cselect_b32 s80, s80, 0x7fff0000
  v_lshlrev_b32 v147, s79, v0
  buffer_load_dword v146, v147, s[12:15], s80 offen
  s_load_dwordx2 s[76:77], s[0:1], 80
  v_lshrrev_b32 v145, 3, v0
  v_and_b32 v144, 3, v145
  s_lshl_b32 s79, s83, 2
  v_add_u32 v144, s79, v144
  v_lshlrev_b32 v144, 5, v144
  s_sub_u32 s79, 32, s81
  s_cmp_eq_u32 s81, 0
  s_cselect_b32 s79, 16, s79
  v_mov_b32 v143, s79
  v_mov_b32 v142, s81
  v_cmp_gt_u32 vcc, 4, v145
  s_nop 1
  v_cndmask_b32 v143, v143, v142, vcc
  v_add_u32 v144, v144, v143
  v_lshlrev_b32 v144, 10, v144
  v_and_b32 v143, 7, v0
  v_lshl_add_u32 v144, v143, 7, v144
  s_waitcnt lgkmcnt(0)
  s_and_b32 s77, s77, 0xffff
  s_mov_b32 s78, 2097152
  s_mov_b32 s79, 0x20000
  s_cmp_eq_u32 s33, 0
  s_cselect_b32 s80, 0, 0x7fff0000
  buffer_load_dword v141, v144, s[76:79], s80 offen
  s_mov_b32 s24, s42
  s_and_b32 s25, s43, 0xffff
  s_mov_b32 s26, 23552
  s_mov_b32 s27, 0x20000
  v_lshlrev_b32 v149, 4, v0
  s_lshl_b32 s82, s33, 2
  s_add_u32 s82, s82, 0
  s_min_u32 s82, s82, 12
  s_lshl_b32 s82, s82, 10
  s_add_u32 s83, s82, 34816
  s_mov_b32 m0, s83
  s_add_u32 s82, s82, 4096
  buffer_load_dwordx4 v149, s[24:27], s82 offen lds
  s_lshl_b32 s82, s33, 2
  s_add_u32 s82, s82, 1
  s_min_u32 s82, s82, 12
  s_lshl_b32 s82, s82, 10
  s_add_u32 s83, s82, 34816
  s_mov_b32 m0, s83
  s_add_u32 s82, s82, 4096
  buffer_load_dwordx4 v149, s[24:27], s82 offen lds
  s_lshl_b32 s82, s33, 2
  s_add_u32 s82, s82, 2
  s_min_u32 s82, s82, 12
  s_lshl_b32 s82, s82, 10
  s_add_u32 s83, s82, 34816
  s_mov_b32 m0, s83
  s_add_u32 s82, s82, 4096
  buffer_load_dwordx4 v149, s[24:27], s82 offen lds
  s_lshl_b32 s82, s33, 2
  s_add_u32 s82, s82, 3
  s_min_u32 s82, s82, 12
  s_lshl_b32 s82, s82, 10
  s_add_u32 s83, s82, 34816
  s_mov_b32 m0, s83
  s_add_u32 s82, s82, 4096
  buffer_load_dwordx4 v149, s[24:27], s82 offen lds
  s_mov_b32 m0, s71
  s_add_u32 s71, s71, 1024
  buffer_load_dwordx4 v154, s[72:75], s70 offen lds
  s_mov_b32 m0, s71
  s_add_u32 s71, s71, 1024
  buffer_load_dwordx4 v155, s[72:75], s70 offen lds
  s_mov_b32 m0, s71
  s_add_u32 s71, s71, 1024
  buffer_load_dwordx4 v156, s[72:75], s70 offen lds
  s_add_u32 s70, s70, 114688
  s_mov_b32 m0, s71
  s_add_u32 s71, s71, 1024
  buffer_load_dwordx4 v150, s[72:75], s70 offen lds
  s_mov_b32 m0, s71
  s_add_u32 s71, s71, 1024
  buffer_load_dwordx4 v151, s[72:75], s70 offen lds
  s_mov_b32 m0, s71
  s_add_u32 s71, s71, 1024
  buffer_load_dwordx4 v152, s[72:75], s70 offen lds
  s_mov_b32 m0, s71
  s_add_u32 s71, s71, 1024
  buffer_load_dwordx4 v153, s[72:75], s70 offen lds
  s_mov_b32 m0, s71
  s_add_u32 s71, s71, 1024
  buffer_load_dwordx4 v154, s[72:75], s70 offen lds
  s_mov_b32 m0, s71
  s_add_u32 s71, s71, 1024
  buffer_load_dwordx4 v155, s[72:75], s70 offen lds
  s_mov_b32 m0, s71
  s_add_u32 s71, s71, 1024
  buffer_load_dwordx4 v156, s[72:75], s70 offen lds
  s_add_u32 s70, s70, 114688
  s_mov_b32 m0, s71
  s_add_u32 s71, s71, 1024
  buffer_load_dwordx4 v150, s[72:75], s70 offen lds
  s_mov_b32 m0, s71
  s_add_u32 s71, s71, 1024
  buffer_load_dwordx4 v151, s[72:75], s70 offen lds
  s_mov_b32 m0, s71
  s_add_u32 s71, s71, 1024
  buffer_load_dwordx4 v152, s[72:75], s70 offen lds
  s_mov_b32 m0, s71
  s_add_u32 s71, s71, 1024
  buffer_load_dwordx4 v153, s[72:75], s70 offen lds
  s_mov_b32 m0, s71
  s_add_u32 s71, s71, 1024
  buffer_load_dwordx4 v154, s[72:75], s70 offen lds
  s_mov_b32 m0, s71
  s_add_u32 s71, s71, 1024
  buffer_load_dwordx4 v155, s[72:75], s70 offen lds
  s_mov_b32 m0, s71
  s_add_u32 s71, s71, 1024
  buffer_load_dwordx4 v156, s[72:75], s70 offen lds
  s_add_u32 s70, s70, 114688
  s_getreg_b32 s82, hwreg(HW_REG_XCC_ID)
  s_and_b32 s82, s82, 15
  s_add_u32 s82, s82, 1
  s_load_dwordx2 s[38:39], s[0:1], 96
  s_load_dwordx2 s[36:37], s[0:1], 0
  s_load_dwordx2 s[40:41], s[0:1], 48
  s_load_dwordx2 s[42:43], s[0:1], 80
  v_lshrrev_b32 v1, 4, v0
  v_and_b32 v2, 15, v0
  s_and_b32 s34, s2, 7
  s_lshr_b32 s35, s2, 3
  s_lshr_b32 s44, s35, 4
  s_lshl_b32 s34, s34, 1
  s_add_u32 s34, s34, s44
  s_and_b32 s35, s35, 15
  v_lshlrev_b32 v3, 4, v0
  v_lshlrev_b32 v4, 13, v1
  v_lshl_add_u32 v4, v2, 4, v4
  s_lshl_b32 s46, s33, 9
  v_add_u32 v4, s46, v4
  s_and_b32 s49, s35, 3
  s_lshl_b32 s47, s34, 17
  s_add_u32 s50, s49, 0
  s_and_b32 s50, s50, 3
  s_lshl_b32 s44, s50, 15
  s_add_u32 s54, s47, s44
  s_lshl_b32 s62, s50, 4
  s_add_u32 s50, s49, 1
  s_and_b32 s50, s50, 3
  s_lshl_b32 s44, s50, 15
  s_add_u32 s55, s47, s44
  s_lshl_b32 s63, s50, 4
  s_add_u32 s50, s49, 2
  s_and_b32 s50, s50, 3
  s_lshl_b32 s44, s50, 15
  s_add_u32 s56, s47, s44
  s_lshl_b32 s64, s50, 4
  s_add_u32 s50, s49, 3
  s_and_b32 s50, s50, 3
  s_lshl_b32 s44, s50, 15
  s_add_u32 s57, s47, s44
  s_lshl_b32 s65, s50, 4
  s_waitcnt lgkmcnt(0)
  s_mov_b32 s8, s38
  s_and_b32 s9, s39, 0xffff
  s_mov_b32 s10, 19922944
  s_mov_b32 s11, 0x20000
  s_lshl_b32 s60, s33, 13
  s_add_u32 s60, s60, 8454144
  v_lshlrev_b32 v6, 7, v0
  s_mov_b32 s61, 65536
adaLN_cond__spectral_fnet__dense_activation_relu__prompt_kernel_pa:
  buffer_load_dword v5, v6, s[8:11], s60 offen sc1
  s_sub_u32 s61, s61, 1
  s_waitcnt vmcnt(0)
  v_xor_b32 v5, s101, v5
  v_add_u32 v5, -1, v5
  v_cmp_lt_u32 vcc, 7, v5
  s_cmp_eq_u32 s61, 0
  s_cbranch_scc1 adaLN_cond__spectral_fnet__dense_activation_relu__prompt_kernel_pad
  s_cbranch_vccnz adaLN_cond__spectral_fnet__dense_activation_relu__prompt_kernel_pa
adaLN_cond__spectral_fnet__dense_activation_relu__prompt_kernel_pad:
  s_barrier
  s_mov_b32 s72, 0x3b000000
  s_mov_b32 s73, 0x3b000000
  buffer_load_dwordx4 v[128:131], v4, s[8:11], s54 offen offset:0 sc1
  buffer_load_dwordx4 v[144:147], v4, s[8:11], s54 offen offset:256 sc1
  s_sub_u32 s48, 32, s34
  s_cmp_eq_u32 s34, 0
  s_cselect_b32 s48, 16, s48
  s_cselect_b64 s[52:53], -1, 0
  v_lshrrev_b32 v5, 3, v2
  v_cmp_eq_u32 vcc, 1, v5
  v_mov_b32 v6, s34
  v_mov_b32 v7, s48
  v_cndmask_b32 v6, v6, v7, vcc
  buffer_load_dwordx4 v[132:135], v4, s[8:11], s54 offen offset:2048 sc1
  v_bfe_u32 v7, v2, 1, 2
  s_lshl_b32 s50, s35, 2
  v_add_u32 v7, s50, v7
  v_lshl_add_u32 v6, v7, 5, v6
  v_cvt_f32_u32 v6, v6
  v_mul_f32 v6, 0x3a000000, v6
  v_and_b32 v7, 1, v2
  v_cvt_f32_u32 v8, v7
  v_mul_f32 v8, 0x3e800000, v8
  buffer_load_dwordx4 v[148:151], v4, s[8:11], s54 offen offset:2304 sc1
  v_cvt_f32_u32 v9, v5
  v_mul_f32 v9, 0.5, v9
  v_add_f32 v9, 0xbe800000, v9
  v_add_f32 v9, v9, v8
  v_cndmask_b32 v9, v9, v8, s[52:53]
  v_mov_b32 v10, v6
  v_mov_b32 v11, v6
  s_and_b64 s[50:51], vcc, s[52:53]
  s_andn2_b64 s[52:53], s[52:53], vcc
  s_add_u32 s54, s54, 4096
  buffer_load_dwordx4 v[136:139], v4, s[8:11], s54 offen offset:0 sc1
  v_mov_b32 v12, 0x3e800000
  v_cndmask_b32 v10, v10, 0, s[50:51]
  v_cndmask_b32 v8, v8, v12, s[50:51]
  v_cndmask_b32 v11, v11, 0, s[52:53]
  v_cndmask_b32 v9, v9, v12, s[52:53]
  v_lshlrev_b32 v5, 2, v1
  v_lshlrev_b32 v7, 31, v7
  v_lshrrev_b32 v12, 16, v7
  v_or_b32 v7, v7, v12
  buffer_load_dwordx4 v[152:155], v4, s[8:11], s54 offen offset:256 sc1
  v_add_u32 v12, s62, v5
  v_cvt_f32_u32 v12, v12
  v_fma_f32 v13, v12, v10, v8
  v_fma_f32 v12, v12, v11, v9
  v_cos_f32 v15, v13
  v_cos_f32 v14, v12
  v_add_f32 v13, v13, v10
  v_add_f32 v12, v12, v11
  v_cvt_pk_bf16_f32 v16, v15, v14
  buffer_load_dwordx4 v[140:143], v4, s[8:11], s54 offen offset:2048 sc1
  v_cos_f32 v15, v13
  v_cos_f32 v14, v12
  v_add_f32 v13, v13, v10
  v_add_f32 v12, v12, v11
  v_cvt_pk_bf16_f32 v17, v15, v14
  v_cos_f32 v15, v13
  v_cos_f32 v14, v12
  v_add_f32 v13, v13, v10
  v_add_f32 v12, v12, v11
  buffer_load_dwordx4 v[156:159], v4, s[8:11], s54 offen offset:2304 sc1
  v_cvt_pk_bf16_f32 v18, v15, v14
  v_cos_f32 v15, v13
  v_cos_f32 v14, v12
  s_nop 0
  v_cvt_pk_bf16_f32 v19, v15, v14
  v_add_u32 v12, s63, v5
  v_cvt_f32_u32 v12, v12
  v_fma_f32 v13, v12, v10, v8
  v_fma_f32 v12, v12, v11, v9
  v_cos_f32 v15, v13
  buffer_load_dwordx4 v[160:163], v4, s[8:11], s55 offen offset:0 sc1
  v_cos_f32 v14, v12
  v_add_f32 v13, v13, v10
  v_add_f32 v12, v12, v11
  v_cvt_pk_bf16_f32 v20, v15, v14
  v_cos_f32 v15, v13
  buffer_load_dwordx4 v[176:179], v4, s[8:11], s55 offen offset:256 sc1
  v_cos_f32 v14, v12
  v_add_f32 v13, v13, v10
  v_add_f32 v12, v12, v11
  v_cvt_pk_bf16_f32 v21, v15, v14
  v_cos_f32 v15, v13
  buffer_load_dwordx4 v[164:167], v4, s[8:11], s55 offen offset:2048 sc1
  v_cos_f32 v14, v12
  v_add_f32 v13, v13, v10
  v_add_f32 v12, v12, v11
  v_cvt_pk_bf16_f32 v22, v15, v14
  v_cos_f32 v15, v13
  buffer_load_dwordx4 v[180:183], v4, s[8:11], s55 offen offset:2304 sc1
  v_cos_f32 v14, v12
  s_nop 0
  v_cvt_pk_bf16_f32 v23, v15, v14
  v_add_u32 v12, s64, v5
  v_cvt_f32_u32 v12, v12
  v_fma_f32 v13, v12, v10, v8
  s_add_u32 s55, s55, 4096
  buffer_load_dwordx4 v[168:171], v4, s[8:11], s55 offen offset:0 sc1
  v_fma_f32 v12, v12, v11, v9
  v_cos_f32 v15, v13
  v_cos_f32 v14, v12
  v_add_f32 v13, v13, v10
  v_add_f32 v12, v12, v11
  buffer_load_dwordx4 v[184:187], v4, s[8:11], s55 offen offset:256 sc1
  v_cvt_pk_bf16_f32 v24, v15, v14
  v_cos_f32 v15, v13
  v_cos_f32 v14, v12
  v_add_f32 v13, v13, v10
  v_add_f32 v12, v12, v11
  buffer_load_dwordx4 v[172:175], v4, s[8:11], s55 offen offset:2048 sc1
  v_cvt_pk_bf16_f32 v25, v15, v14
  v_cos_f32 v15, v13
  v_cos_f32 v14, v12
  v_add_f32 v13, v13, v10
  v_add_f32 v12, v12, v11
  buffer_load_dwordx4 v[188:191], v4, s[8:11], s55 offen offset:2304 sc1
  v_cvt_pk_bf16_f32 v26, v15, v14
  v_cos_f32 v15, v13
  v_cos_f32 v14, v12
  s_nop 0
  v_cvt_pk_bf16_f32 v27, v15, v14
  s_mul_i32 s44, s33, 2048
  s_add_u32 s45, s44, 8392704
  s_add_u32 s44, s44, 0
  v_add_u32 v12, s65, v5
  v_cvt_f32_u32 v12, v12
  v_fma_f32 v13, v12, v10, v8
  v_fma_f32 v12, v12, v11, v9
  s_mov_b32 m0, s44
  s_add_u32 s44, s44, 1024
  buffer_load_dwordx4 v3, s[8:11], s45 offen sc1 lds
  s_add_u32 s45, s45, 1024
  v_cos_f32 v15, v13
  v_cos_f32 v14, v12
  v_add_f32 v13, v13, v10
  v_add_f32 v12, v12, v11
  s_mov_b32 m0, s44
  s_add_u32 s44, s44, 1024
  buffer_load_dwordx4 v3, s[8:11], s45 offen sc1 lds
  v_cvt_pk_bf16_f32 v28, v15, v14
  v_cos_f32 v15, v13
  v_cos_f32 v14, v12
  v_add_f32 v13, v13, v10
  v_add_f32 v12, v12, v11
  v_cvt_pk_bf16_f32 v29, v15, v14
  v_cos_f32 v15, v13
  v_cos_f32 v14, v12
  v_add_f32 v13, v13, v10
  v_add_f32 v12, v12, v11
  v_cvt_pk_bf16_f32 v30, v15, v14
  v_cos_f32 v15, v13
  v_cos_f32 v14, v12
  s_nop 0
  v_cvt_pk_bf16_f32 v31, v15, v14
  s_mov_b32 s12, s36
  s_and_b32 s13, s37, 0xffff
  s_mov_b32 s14, 2097152
  s_mov_b32 s15, 0x20000
  s_mov_b32 s16, s40
  s_and_b32 s17, s41, 0xffff
  s_mov_b32 s18, 1835008
  s_mov_b32 s19, 0x20000
  s_mov_b32 s20, s42
  s_and_b32 s21, s43, 0xffff
  s_mov_b32 s22, 2097152
  s_mov_b32 s23, 0x20000
  s_lshr_b32 s60, s33, 1
  s_cmp_eq_u32 s60, 1
  s_cselect_b32 s60, s48, s34
  s_and_b32 s61, s33, 1
  s_lshl_b32 s61, s61, 1
  s_lshl_b32 s58, s35, 2
  s_add_u32 s61, s61, s58
  s_lshl_b32 s61, s61, 5
  s_add_u32 s61, s61, s60
  s_lshl_b32 s58, s61, 10
  s_add_u32 s59, s58, 32768
  v_bfe_u32 v12, v0, 4, 1
  v_lshlrev_b32 v12, 8, v12
  v_lshrrev_b32 v13, 5, v0
  v_lshl_add_u32 v12, v13, 6, v12
  v_and_b32 v13, 3, v0
  v_lshl_add_u32 v12, v13, 4, v12
  v_bfe_u32 v13, v0, 2, 2
  v_lshl_add_u32 v12, v13, 2, v12
  v_add_u32 v12, s33, v12
  v_lshlrev_b32 v12, 2, v12
  s_lshl_b32 s44, s33, 9
  s_add_u32 s44, s44, 8192
  s_mov_b32 s45, 8390656
  s_mov_b32 m0, s44
  s_nop 0
  buffer_load_dword v12, s[8:11], s45 offen sc1 lds
  s_add_u32 s44, s44, 256
  s_mov_b32 s45, 8391168
  s_mov_b32 m0, s44
  s_nop 0
  buffer_load_dword v12, s[8:11], s45 offen sc1 lds
  s_or_b32 s60, s34, s35
  s_cmp_lg_u32 s60, 0
  s_cbranch_scc1 adaLN_cond__spectral_fnet__dense_activation_relu__prompt_kernel_nosap
  v_bfe_u32 v12, v0, 4, 1
  v_lshlrev_b32 v12, 8, v12
  v_lshrrev_b32 v13, 5, v0
  v_lshl_add_u32 v12, v13, 6, v12
  v_and_b32 v13, 3, v0
  v_lshl_add_u32 v12, v13, 4, v12
  v_bfe_u32 v13, v0, 2, 2
  v_lshl_add_u32 v12, v13, 2, v12
  v_add_u32 v12, s33, v12
  v_lshlrev_b32 v12, 2, v12
  s_lshl_b32 s44, s33, 9
  s_add_u32 s44, s44, 10240
  s_mov_b32 s45, 8388608
  s_mov_b32 m0, s44
  s_nop 0
  buffer_load_dword v12, s[8:11], s45 offen sc1 lds
  s_add_u32 s44, s44, 256
  s_mov_b32 s45, 8389120
  s_mov_b32 m0, s44
  s_nop 0
  buffer_load_dword v12, s[8:11], s45 offen sc1 lds
  s_waitcnt vmcnt(0)
adaLN_cond__spectral_fnet__dense_activation_relu__prompt_kernel_nosap:
  v_lshlrev_b32 v14, 6, v2
  v_lshl_add_u32 v14, v1, 3, v14
  s_waitcnt vmcnt(13)
  v_swap_b32 v129, v132
  v_swap_b32 v130, v136
  buffer_load_dwordx4 v[192:195], v4, s[8:11], s56 offen offset:0 sc1
  v_swap_b32 v131, v140
  v_swap_b32 v134, v137
  v_swap_b32 v135, v141
  buffer_load_dwordx4 v[208:211], v4, s[8:11], s56 offen offset:256 sc1
  v_swap_b32 v139, v142
  v_mfma_f32_16x16x32_bf16 v[64:67], v[128:131], v[16:19], 0
  v_mfma_f32_16x16x32_bf16 v[68:71], v[132:135], v[16:19], 0
  buffer_load_dwordx4 v[196:199], v4, s[8:11], s56 offen offset:2048 sc1
  v_mfma_f32_16x16x32_bf16 v[72:75], v[136:139], v[16:19], 0
  v_mfma_f32_16x16x32_bf16 v[76:79], v[140:143], v[16:19], 0
  s_waitcnt vmcnt(15)
  buffer_load_dwordx4 v[212:215], v4, s[8:11], s56 offen offset:2304 sc1
  v_swap_b32 v145, v148
  v_swap_b32 v146, v152
  v_swap_b32 v147, v156
  s_add_u32 s56, s56, 4096
  buffer_load_dwordx4 v[200:203], v4, s[8:11], s56 offen offset:0 sc1
  v_swap_b32 v150, v153
  v_swap_b32 v151, v157
  v_swap_b32 v155, v158
  buffer_load_dwordx4 v[216:219], v4, s[8:11], s56 offen offset:256 sc1
  v_mfma_f32_16x16x32_bf16 v[80:83], v[144:147], v[16:19], 0
  v_mfma_f32_16x16x32_bf16 v[84:87], v[148:151], v[16:19], 0
  v_mfma_f32_16x16x32_bf16 v[88:91], v[152:155], v[16:19], 0
  buffer_load_dwordx4 v[204:207], v4, s[8:11], s56 offen offset:2048 sc1
  v_mfma_f32_16x16x32_bf16 v[92:95], v[156:159], v[16:19], 0
  buffer_load_dwordx4 v[220:223], v4, s[8:11], s56 offen offset:2304 sc1
  s_waitcnt vmcnt(13)
  v_swap_b32 v161, v164
  v_swap_b32 v162, v168
  buffer_load_dwordx4 v[224:227], v4, s[8:11], s57 offen offset:0 sc1
  v_swap_b32 v163, v172
  v_swap_b32 v166, v169
  v_swap_b32 v167, v173
  buffer_load_dwordx4 v[240:243], v4, s[8:11], s57 offen offset:256 sc1
  v_swap_b32 v171, v174
  v_mfma_f32_16x16x32_bf16 v[64:67], v[160:163], v[20:23], v[64:67]
  v_mfma_f32_16x16x32_bf16 v[68:71], v[164:167], v[20:23], v[68:71]
  buffer_load_dwordx4 v[228:231], v4, s[8:11], s57 offen offset:2048 sc1
  v_mfma_f32_16x16x32_bf16 v[72:75], v[168:171], v[20:23], v[72:75]
  v_mfma_f32_16x16x32_bf16 v[76:79], v[172:175], v[20:23], v[76:79]
  s_waitcnt vmcnt(15)
  buffer_load_dwordx4 v[244:247], v4, s[8:11], s57 offen offset:2304 sc1
  v_swap_b32 v177, v180
  v_swap_b32 v178, v184
  v_swap_b32 v179, v188
  s_add_u32 s57, s57, 4096
  buffer_load_dwordx4 v[232:235], v4, s[8:11], s57 offen offset:0 sc1
  v_swap_b32 v182, v185
  v_swap_b32 v183, v189
  v_swap_b32 v187, v190
  buffer_load_dwordx4 v[248:251], v4, s[8:11], s57 offen offset:256 sc1
  v_mfma_f32_16x16x32_bf16 v[80:83], v[176:179], v[20:23], v[80:83]
  v_mfma_f32_16x16x32_bf16 v[84:87], v[180:183], v[20:23], v[84:87]
  v_mfma_f32_16x16x32_bf16 v[88:91], v[184:187], v[20:23], v[88:91]
  buffer_load_dwordx4 v[236:239], v4, s[8:11], s57 offen offset:2048 sc1
  v_mfma_f32_16x16x32_bf16 v[92:95], v[188:191], v[20:23], v[92:95]
  buffer_load_dwordx4 v[252:255], v4, s[8:11], s57 offen offset:2304 sc1
  s_waitcnt vmcnt(16)
  s_barrier
  s_lshl_b32 s60, s33, 2
  v_add_u32 v12, s60, v1
  v_lshlrev_b32 v13, 7, v12
  v_and_b32 v15, 1, v2
  v_lshl_add_u32 v12, v12, 1, v15
  v_lshlrev_b32 v12, 8, v12
  v_lshlrev_b32 v15, 1, v14
  buffer_load_dwordx2 v[184:185], v14, s[12:15], s58 offen offset:0
  buffer_load_dwordx2 v[186:187], v14, s[12:15], s58 offen offset:32
  buffer_load_dwordx2 v[188:189], v14, s[12:15], s59 offen offset:0
  buffer_load_dwordx2 v[190:191], v14, s[12:15], s59 offen offset:32
  ds_read_b128 v[32:35], v13 offset:8192
  ds_read_b128 v[36:39], v13 offset:8208
  ds_read_b128 v[40:43], v13 offset:8224
  ds_read_b128 v[44:47], v13 offset:8240
  ds_read_b128 v[48:51], v13 offset:8256
  ds_read_b128 v[52:55], v13 offset:8272
  ds_read_b128 v[56:59], v13 offset:8288
  ds_read_b128 v[60:63], v13 offset:8304
  s_waitcnt vmcnt(13)
  ds_read_b128 a[0:3], v3 offset:34816
  v_swap_b32 v193, v196
  ds_read_b128 a[4:7], v3 offset:35840
  v_swap_b32 v194, v200
  ds_read_b128 a[8:11], v3 offset:36864
  v_swap_b32 v195, v204
  ds_read_b128 a[12:15], v3 offset:37888
  v_swap_b32 v198, v201
  s_waitcnt lgkmcnt(8)
  ds_read_b128 v[96:99], v12 offset:38912
  v_swap_b32 v199, v205
  ds_read_b128 v[100:103], v12 offset:38928
  v_swap_b32 v203, v206
  ds_read_b128 v[104:107], v12 offset:38944
  v_mfma_f32_16x16x32_bf16 v[64:67], v[192:195], v[24:27], v[64:67]
  ds_read_b128 v[108:111], v12 offset:38960
  v_mfma_f32_16x16x32_bf16 v[68:71], v[196:199], v[24:27], v[68:71]
  s_waitcnt lgkmcnt(8)
  ds_read_b128 v[112:115], v12 offset:38976
  v_mfma_f32_16x16x32_bf16 v[72:75], v[200:203], v[24:27], v[72:75]
  ds_read_b128 v[116:119], v12 offset:38992
  v_mfma_f32_16x16x32_bf16 v[76:79], v[204:207], v[24:27], v[76:79]
  ds_read_b128 v[120:123], v12 offset:39008
  s_waitcnt vmcnt(12)
  ds_read_b128 v[124:127], v12 offset:39024
  v_swap_b32 v209, v212
  s_waitcnt lgkmcnt(8)
  ds_read_b128 v[128:131], v12 offset:39040
  v_swap_b32 v210, v216
  ds_read_b128 v[132:135], v12 offset:39056
  v_swap_b32 v211, v220
  v_swap_b32 v214, v217
  v_swap_b32 v215, v221
  v_swap_b32 v219, v222
  v_mfma_f32_16x16x32_bf16 v[80:83], v[208:211], v[24:27], v[80:83]
  v_mfma_f32_16x16x32_bf16 v[84:87], v[212:215], v[24:27], v[84:87]
  v_mfma_f32_16x16x32_bf16 v[88:91], v[216:219], v[24:27], v[88:91]
  v_mfma_f32_16x16x32_bf16 v[92:95], v[220:223], v[24:27], v[92:95]
  s_mov_b32 s74, s70
  s_mov_b32 s75, s71
  v_add_u32 v13, 0, v0
  v_mul_u32_u24 v4, 4682, v13
  v_lshrrev_b32 v4, 16, v4
  v_mad_i32_i24 v13, v4, -14, v13
  v_mul_u32_u24 v4, 3584, v4
  v_lshl_add_u32 v4, v13, 4, v4
  v_add_u32 v13, 64, v0
  v_mul_u32_u24 v8, 4682, v13
  v_lshrrev_b32 v8, 16, v8
  v_mad_i32_i24 v13, v8, -14, v13
  v_mul_u32_u24 v8, 3584, v8
  v_lshl_add_u32 v8, v13, 4, v8
  v_add_u32 v13, 128, v0
  v_mul_u32_u24 v9, 4682, v13
  v_lshrrev_b32 v9, 16, v9
  v_mad_i32_i24 v13, v9, -14, v13
  v_mul_u32_u24 v9, 3584, v9
  v_lshl_add_u32 v9, v13, 4, v9
  v_add_u32 v13, 192, v0
  v_mul_u32_u24 v10, 4682, v13
  v_lshrrev_b32 v10, 16, v10
  v_mad_i32_i24 v13, v10, -14, v13
  v_mul_u32_u24 v10, 3584, v10
  v_lshl_add_u32 v10, v13, 4, v10
  v_add_u32 v13, 256, v0
  v_mul_u32_u24 v11, 4682, v13
  v_lshrrev_b32 v11, 16, v11
  v_mad_i32_i24 v13, v11, -14, v13
  v_mul_u32_u24 v11, 3584, v11
  v_lshl_add_u32 v11, v13, 4, v11
  v_add_u32 v13, 320, v0
  v_mul_u32_u24 v16, 4682, v13
  v_lshrrev_b32 v16, 16, v16
  v_mad_i32_i24 v13, v16, -14, v13
  v_mul_u32_u24 v16, 3584, v16
  v_lshl_add_u32 v16, v13, 4, v16
  v_add_u32 v13, 384, v0
  v_mul_u32_u24 v17, 4682, v13
  v_lshrrev_b32 v17, 16, v17
  v_mad_i32_i24 v13, v17, -14, v13
  v_mul_u32_u24 v17, 3584, v17
  v_lshl_add_u32 v17, v13, 4, v17
  s_mul_i32 s70, s33, 458752
  s_mul_i32 s71, s35, 224
  s_add_u32 s70, s70, s71
  s_mul_i32 s71, s33, 28672
  s_add_u32 s71, s71, 49152
  s_mov_b32 s70, s74
  s_mov_b32 s71, s75
  s_and_b32 s67, s34, 1
  s_lshl_b32 s67, s67, 7
  s_lshr_b32 s66, s34, 1
  s_add_u32 s67, s67, s66
  s_lshl_b32 s67, s67, 7
  s_add_u32 s67, s67, 8454144
  v_lshlrev_b32 v13, 10, v2
  buffer_load_dword a20, v13, s[8:11], s67 offen sc1
  s_mul_i32 s68, s34, 458752
  s_mul_i32 s69, s35, 21504
  s_add_u32 s68, s68, s69
  s_lshl_b32 s69, s33, 13
  s_add_u32 s68, s68, s69
  s_add_u32 s68, s68, 10600448
  s_cmp_eq_u32 s33, 3
  s_cselect_b32 s68, 0x7fff0000, s68
  v_lshlrev_b32 v6, 7, v0
  buffer_load_dword a250, v6, s[8:11], s68 offen
  s_waitcnt vmcnt(7)
  ds_read_b128 v[136:139], v12 offset:39072
  v_swap_b32 v225, v228
  ds_read_b128 v[140:143], v12 offset:39088
  v_swap_b32 v226, v232
  s_waitcnt lgkmcnt(8)
  ds_read_b128 v[144:147], v12 offset:39104
  v_swap_b32 v227, v236
  ds_read_b128 v[148:151], v12 offset:39120
  v_swap_b32 v230, v233
  ds_read_b128 v[152:155], v12 offset:39136
  v_swap_b32 v231, v237
  ds_read_b128 v[156:159], v12 offset:39152
  v_swap_b32 v235, v238
  s_waitcnt lgkmcnt(8)
  ds_read_b128 v[160:163], v15 offset:0
  v_mfma_f32_16x16x32_bf16 v[64:67], v[224:227], v[28:31], v[64:67]
  ds_read_b128 v[164:167], v15 offset:64
  v_mfma_f32_16x16x32_bf16 v[68:71], v[228:231], v[28:31], v[68:71]
  ds_read_b128 v[168:171], v15 offset:4096
  v_mfma_f32_16x16x32_bf16 v[72:75], v[232:235], v[28:31], v[72:75]
  ds_read_b128 v[172:175], v15 offset:4160
  v_mfma_f32_16x16x32_bf16 v[76:79], v[236:239], v[28:31], v[76:79]
  s_waitcnt lgkmcnt(8)
  ds_read_b128 v[176:179], v15 offset:2048
  s_waitcnt vmcnt(6)
  ds_read_b128 v[180:183], v15 offset:2112
  v_swap_b32 v241, v244
  ds_read_b128 a[16:19], v3 offset:47104
  v_swap_b32 v242, v248
  v_swap_b32 v243, v252
  v_swap_b32 v246, v249
  v_swap_b32 v247, v253
  v_swap_b32 v251, v254
  v_mfma_f32_16x16x32_bf16 v[80:83], v[240:243], v[28:31], v[80:83]
  v_mfma_f32_16x16x32_bf16 v[84:87], v[244:247], v[28:31], v[84:87]
  v_mfma_f32_16x16x32_bf16 v[88:91], v[248:251], v[28:31], v[88:91]
  v_mfma_f32_16x16x32_bf16 v[92:95], v[252:255], v[28:31], v[92:95]
  s_mov_b32 m0, s71
  s_add_u32 s71, s71, 1024
  buffer_load_dwordx4 v4, s[16:19], s70 offen lds
  s_waitcnt lgkmcnt(0)
  s_or_b32 s60, s34, s35
  s_cmp_lg_u32 s60, 0
  s_cbranch_scc1 adaLN_cond__spectral_fnet__dense_activation_relu__prompt_kernel_nosa
  s_lshl_b32 s60, s33, 2
  v_add_u32 v15, s60, v1
  v_lshlrev_b32 v15, 7, v15
  ds_read_b128 v[192:195], v15 offset:10240
  ds_read_b128 v[196:199], v15 offset:10256
  ds_read_b128 v[200:203], v15 offset:10272
  ds_read_b128 v[204:207], v15 offset:10288
  ds_read_b128 v[208:211], v15 offset:10304
  ds_read_b128 v[212:215], v15 offset:10320
  ds_read_b128 v[216:219], v15 offset:10336
  ds_read_b128 v[220:223], v15 offset:10352
  v_cmp_eq_u32 vcc, 0, v2
  v_mov_b32 v15, 0x45000000
  s_nop 0
  v_cndmask_b32 v15, 0, v15, vcc
  s_waitcnt lgkmcnt(0)
  s_nop 7
  v_mul_f32 v64, v64, v32
  v_fmac_f32 v64, v15, v192
  v_mov_b32 v32, 1.0
  v_mul_f32 v65, v65, v33
  v_fmac_f32 v65, v15, v193
  v_mov_b32 v33, 1.0
  v_mul_f32 v66, v66, v34
  v_fmac_f32 v66, v15, v194
  v_mov_b32 v34, 1.0
  v_mul_f32 v67, v67, v35
  v_fmac_f32 v67, v15, v195
  v_mov_b32 v35, 1.0
  v_mul_f32 v68, v68, v36
  v_fmac_f32 v68, v15, v196
  v_mov_b32 v36, 1.0
  v_mul_f32 v69, v69, v37
  v_fmac_f32 v69, v15, v197
  v_mov_b32 v37, 1.0
  v_mul_f32 v70, v70, v38
  v_fmac_f32 v70, v15, v198
  v_mov_b32 v38, 1.0
  v_mul_f32 v71, v71, v39
  v_fmac_f32 v71, v15, v199
  v_mov_b32 v39, 1.0
  v_mul_f32 v72, v72, v40
  v_fmac_f32 v72, v15, v200
  v_mov_b32 v40, 1.0
  v_mul_f32 v73, v73, v41
  v_fmac_f32 v73, v15, v201
  v_mov_b32 v41, 1.0
  v_mul_f32 v74, v74, v42
  v_fmac_f32 v74, v15, v202
  v_mov_b32 v42, 1.0
  v_mul_f32 v75, v75, v43
  v_fmac_f32 v75, v15, v203
  v_mov_b32 v43, 1.0
  v_mul_f32 v76, v76, v44
  v_fmac_f32 v76, v15, v204
  v_mov_b32 v44, 1.0
  v_mul_f32 v77, v77, v45
  v_fmac_f32 v77, v15, v205
  v_mov_b32 v45, 1.0
  v_mul_f32 v78, v78, v46
  v_fmac_f32 v78, v15, v206
  v_mov_b32 v46, 1.0
  v_mul_f32 v79, v79, v47
  v_fmac_f32 v79, v15, v207
  v_mov_b32 v47, 1.0
  v_mul_f32 v80, v80, v48
  v_fmac_f32 v80, v15, v208
  v_mov_b32 v48, 1.0
  v_mul_f32 v81, v81, v49
  v_fmac_f32 v81, v15, v209
  v_mov_b32 v49, 1.0
  v_mul_f32 v82, v82, v50
  v_fmac_f32 v82, v15, v210
  v_mov_b32 v50, 1.0
  v_mul_f32 v83, v83, v51
  v_fmac_f32 v83, v15, v211
  v_mov_b32 v51, 1.0
  v_mul_f32 v84, v84, v52
  v_fmac_f32 v84, v15, v212
  v_mov_b32 v52, 1.0
  v_mul_f32 v85, v85, v53
  v_fmac_f32 v85, v15, v213
  v_mov_b32 v53, 1.0
  v_mul_f32 v86, v86, v54
  v_fmac_f32 v86, v15, v214
  v_mov_b32 v54, 1.0
  v_mul_f32 v87, v87, v55
  v_fmac_f32 v87, v15, v215
  v_mov_b32 v55, 1.0
  v_mul_f32 v88, v88, v56
  v_fmac_f32 v88, v15, v216
  v_mov_b32 v56, 1.0
  v_mul_f32 v89, v89, v57
  v_fmac_f32 v89, v15, v217
  v_mov_b32 v57, 1.0
  v_mul_f32 v90, v90, v58
  v_fmac_f32 v90, v15, v218
  v_mov_b32 v58, 1.0
  v_mul_f32 v91, v91, v59
  v_fmac_f32 v91, v15, v219
  v_mov_b32 v59, 1.0
  v_mul_f32 v92, v92, v60
  v_fmac_f32 v92, v15, v220
  v_mov_b32 v60, 1.0
  v_mul_f32 v93, v93, v61
  v_fmac_f32 v93, v15, v221
  v_mov_b32 v61, 1.0
  v_mul_f32 v94, v94, v62
  v_fmac_f32 v94, v15, v222
  v_mov_b32 v62, 1.0
  v_mul_f32 v95, v95, v63
  v_fmac_f32 v95, v15, v223
  v_mov_b32 v63, 1.0
adaLN_cond__spectral_fnet__dense_activation_relu__prompt_kernel_nosa:
  v_pk_mul_f32 v[64:65], v[64:65], v[32:33]
  v_pk_mul_f32 v[66:67], v[66:67], v[34:35]
  v_pk_mul_f32 v[80:81], v[80:81], v[48:49]
  v_pk_mul_f32 v[82:83], v[82:83], v[50:51]
  v_cvt_pk_bf16_f32 v192, v64, v65
  v_cvt_pk_bf16_f32 v193, v66, v67
  v_cvt_pk_bf16_f32 v194, v80, v81
  v_cvt_pk_bf16_f32 v195, v82, v83
  s_mov_b32 m0, s71
  s_add_u32 s71, s71, 1024
  buffer_load_dwordx4 v8, s[16:19], s70 offen lds
  v_xor_b32_dpp v196, v192, v7 quad_perm:[1,0,3,2] row_mask:0xf bank_mask:0xf
  v_xor_b32_dpp v197, v193, v7 quad_perm:[1,0,3,2] row_mask:0xf bank_mask:0xf
  v_xor_b32_dpp v198, v194, v7 quad_perm:[1,0,3,2] row_mask:0xf bank_mask:0xf
  v_xor_b32_dpp v199, v195, v7 quad_perm:[1,0,3,2] row_mask:0xf bank_mask:0xf
  v_mfma_f32_16x16x32_bf16 v[224:227], a[0:3], v[192:195], 0
  v_mfma_f32_16x16x32_bf16 v[240:243], a[8:11], v[192:195], 0
  v_mfma_f32_16x16x32_bf16 v[224:227], a[4:7], v[196:199], v[224:227]
  v_mfma_f32_16x16x32_bf16 v[240:243], a[12:15], v[196:199], v[240:243]
  s_mov_b32 m0, s71
  s_add_u32 s71, s71, 1024
  buffer_load_dwordx4 v9, s[16:19], s70 offen lds
  v_pk_mul_f32 v[68:69], v[68:69], v[36:37]
  v_pk_mul_f32 v[70:71], v[70:71], v[38:39]
  v_pk_mul_f32 v[84:85], v[84:85], v[52:53]
  v_pk_mul_f32 v[86:87], v[86:87], v[54:55]
  v_cvt_pk_bf16_f32 v200, v68, v69
  v_cvt_pk_bf16_f32 v201, v70, v71
  v_cvt_pk_bf16_f32 v202, v84, v85
  v_cvt_pk_bf16_f32 v203, v86, v87
  s_mov_b32 m0, s71
  s_add_u32 s71, s71, 1024
  buffer_load_dwordx4 v10, s[16:19], s70 offen lds
  v_xor_b32_dpp v204, v200, v7 quad_perm:[1,0,3,2] row_mask:0xf bank_mask:0xf
  v_xor_b32_dpp v205, v201, v7 quad_perm:[1,0,3,2] row_mask:0xf bank_mask:0xf
  v_xor_b32_dpp v206, v202, v7 quad_perm:[1,0,3,2] row_mask:0xf bank_mask:0xf
  v_xor_b32_dpp v207, v203, v7 quad_perm:[1,0,3,2] row_mask:0xf bank_mask:0xf
  v_mfma_f32_16x16x32_bf16 v[228:231], a[0:3], v[200:203], 0
  v_mfma_f32_16x16x32_bf16 v[244:247], a[8:11], v[200:203], 0
  v_mfma_f32_16x16x32_bf16 v[228:231], a[4:7], v[204:207], v[228:231]
  v_mfma_f32_16x16x32_bf16 v[244:247], a[12:15], v[204:207], v[244:247]
  s_mov_b32 m0, s71
  s_add_u32 s71, s71, 1024
  buffer_load_dwordx4 v11, s[16:19], s70 offen lds
  v_pk_mul_f32 v[72:73], v[72:73], v[40:41]
  v_pk_mul_f32 v[74:75], v[74:75], v[42:43]
  v_pk_mul_f32 v[88:89], v[88:89], v[56:57]
  v_pk_mul_f32 v[90:91], v[90:91], v[58:59]
  v_cvt_pk_bf16_f32 v208, v72, v73
  v_cvt_pk_bf16_f32 v209, v74, v75
  v_cvt_pk_bf16_f32 v210, v88, v89
  v_cvt_pk_bf16_f32 v211, v90, v91
  s_mov_b32 m0, s71
  s_add_u32 s71, s71, 1024
  buffer_load_dwordx4 v16, s[16:19], s70 offen lds
  v_xor_b32_dpp v212, v208, v7 quad_perm:[1,0,3,2] row_mask:0xf bank_mask:0xf
  v_xor_b32_dpp v213, v209, v7 quad_perm:[1,0,3,2] row_mask:0xf bank_mask:0xf
  v_xor_b32_dpp v214, v210, v7 quad_perm:[1,0,3,2] row_mask:0xf bank_mask:0xf
  v_xor_b32_dpp v215, v211, v7 quad_perm:[1,0,3,2] row_mask:0xf bank_mask:0xf
  v_mfma_f32_16x16x32_bf16 v[232:235], a[0:3], v[208:211], 0
  v_mfma_f32_16x16x32_bf16 v[248:251], a[8:11], v[208:211], 0
  v_mfma_f32_16x16x32_bf16 v[232:235], a[4:7], v[212:215], v[232:235]
  v_mfma_f32_16x16x32_bf16 v[248:251], a[12:15], v[212:215], v[248:251]
  s_mov_b32 m0, s71
  s_add_u32 s71, s71, 1024
  buffer_load_dwordx4 v17, s[16:19], s70 offen lds
  s_add_u32 s70, s70, 114688
  v_pk_mul_f32 v[76:77], v[76:77], v[44:45]
  v_pk_mul_f32 v[78:79], v[78:79], v[46:47]
  v_pk_mul_f32 v[92:93], v[92:93], v[60:61]
  v_pk_mul_f32 v[94:95], v[94:95], v[62:63]
  v_cvt_pk_bf16_f32 v216, v76, v77
  v_cvt_pk_bf16_f32 v217, v78, v79
  v_cvt_pk_bf16_f32 v218, v92, v93
  v_cvt_pk_bf16_f32 v219, v94, v95
  v_xor_b32_dpp v220, v216, v7 quad_perm:[1,0,3,2] row_mask:0xf bank_mask:0xf
  v_xor_b32_dpp v221, v217, v7 quad_perm:[1,0,3,2] row_mask:0xf bank_mask:0xf
  v_xor_b32_dpp v222, v218, v7 quad_perm:[1,0,3,2] row_mask:0xf bank_mask:0xf
  v_xor_b32_dpp v223, v219, v7 quad_perm:[1,0,3,2] row_mask:0xf bank_mask:0xf
  v_mfma_f32_16x16x32_bf16 v[236:239], a[0:3], v[216:219], 0
  v_mfma_f32_16x16x32_bf16 v[252:255], a[8:11], v[216:219], 0
  v_mfma_f32_16x16x32_bf16 v[236:239], a[4:7], v[220:223], v[236:239]
  v_mfma_f32_16x16x32_bf16 v[252:255], a[12:15], v[220:223], v[252:255]
  v_lshrrev_b32 v12, 1, v2
  v_mul_u32_u24 v12, 2064, v12
  v_lshl_add_u32 v12, v1, 8, v12
  v_and_b32 v13, 1, v2
  v_lshl_add_u32 v12, v13, 3, v12
  s_lshl_b32 s60, s33, 4
  v_add_u32 v12, s60, v12
  v_lshlrev_b32 v13, 6, v2
  v_lshl_add_u32 v13, v1, 4, v13
  s_mul_i32 s60, s33, 4128
  v_add_u32 v13, s60, v13
  v_pk_mul_f32 v[96:97], v[224:225], v[96:97]
  v_pk_mul_f32 v[98:99], v[226:227], v[98:99]
  s_nop 0
  v_fmac_f32_dpp v96, v224, v128 quad_perm:[1,0,3,2] row_mask:0xf bank_mask:0xf
  v_fmac_f32_dpp v97, v225, v129 quad_perm:[1,0,3,2] row_mask:0xf bank_mask:0xf
  v_fmac_f32_dpp v98, v226, v130 quad_perm:[1,0,3,2] row_mask:0xf bank_mask:0xf
  v_fmac_f32_dpp v99, v227, v131 quad_perm:[1,0,3,2] row_mask:0xf bank_mask:0xf
  v_pk_mul_f32 v[112:113], v[240:241], v[112:113]
  v_pk_mul_f32 v[114:115], v[242:243], v[114:115]
  s_nop 0
  v_fmac_f32_dpp v112, v240, v144 quad_perm:[1,0,3,2] row_mask:0xf bank_mask:0xf
  v_fmac_f32_dpp v113, v241, v145 quad_perm:[1,0,3,2] row_mask:0xf bank_mask:0xf
  v_fmac_f32_dpp v114, v242, v146 quad_perm:[1,0,3,2] row_mask:0xf bank_mask:0xf
  v_fmac_f32_dpp v115, v243, v147 quad_perm:[1,0,3,2] row_mask:0xf bank_mask:0xf
  v_pk_mul_f32 v[100:101], v[228:229], v[100:101]
  v_pk_mul_f32 v[102:103], v[230:231], v[102:103]
  s_nop 0
  v_fmac_f32_dpp v100, v228, v132 quad_perm:[1,0,3,2] row_mask:0xf bank_mask:0xf
  v_fmac_f32_dpp v101, v229, v133 quad_perm:[1,0,3,2] row_mask:0xf bank_mask:0xf
  v_fmac_f32_dpp v102, v230, v134 quad_perm:[1,0,3,2] row_mask:0xf bank_mask:0xf
  v_fmac_f32_dpp v103, v231, v135 quad_perm:[1,0,3,2] row_mask:0xf bank_mask:0xf
  v_pk_mul_f32 v[116:117], v[244:245], v[116:117]
  v_pk_mul_f32 v[118:119], v[246:247], v[118:119]
  s_nop 0
  v_fmac_f32_dpp v116, v244, v148 quad_perm:[1,0,3,2] row_mask:0xf bank_mask:0xf
  v_fmac_f32_dpp v117, v245, v149 quad_perm:[1,0,3,2] row_mask:0xf bank_mask:0xf
  v_fmac_f32_dpp v118, v246, v150 quad_perm:[1,0,3,2] row_mask:0xf bank_mask:0xf
  v_fmac_f32_dpp v119, v247, v151 quad_perm:[1,0,3,2] row_mask:0xf bank_mask:0xf
  v_pk_mul_f32 v[104:105], v[232:233], v[104:105]
  v_pk_mul_f32 v[106:107], v[234:235], v[106:107]
  s_nop 0
  v_fmac_f32_dpp v104, v232, v136 quad_perm:[1,0,3,2] row_mask:0xf bank_mask:0xf
  v_fmac_f32_dpp v105, v233, v137 quad_perm:[1,0,3,2] row_mask:0xf bank_mask:0xf
  v_fmac_f32_dpp v106, v234, v138 quad_perm:[1,0,3,2] row_mask:0xf bank_mask:0xf
  v_fmac_f32_dpp v107, v235, v139 quad_perm:[1,0,3,2] row_mask:0xf bank_mask:0xf
  v_pk_mul_f32 v[120:121], v[248:249], v[120:121]
  v_pk_mul_f32 v[122:123], v[250:251], v[122:123]
  s_nop 0
  v_fmac_f32_dpp v120, v248, v152 quad_perm:[1,0,3,2] row_mask:0xf bank_mask:0xf
  v_fmac_f32_dpp v121, v249, v153 quad_perm:[1,0,3,2] row_mask:0xf bank_mask:0xf
  v_fmac_f32_dpp v122, v250, v154 quad_perm:[1,0,3,2] row_mask:0xf bank_mask:0xf
  v_fmac_f32_dpp v123, v251, v155 quad_perm:[1,0,3,2] row_mask:0xf bank_mask:0xf
  v_pk_mul_f32 v[108:109], v[236:237], v[108:109]
  v_pk_mul_f32 v[110:111], v[238:239], v[110:111]
  s_nop 0
  v_fmac_f32_dpp v108, v236, v140 quad_perm:[1,0,3,2] row_mask:0xf bank_mask:0xf
  v_fmac_f32_dpp v109, v237, v141 quad_perm:[1,0,3,2] row_mask:0xf bank_mask:0xf
  v_fmac_f32_dpp v110, v238, v142 quad_perm:[1,0,3,2] row_mask:0xf bank_mask:0xf
  v_fmac_f32_dpp v111, v239, v143 quad_perm:[1,0,3,2] row_mask:0xf bank_mask:0xf
  v_pk_mul_f32 v[124:125], v[252:253], v[124:125]
  v_pk_mul_f32 v[126:127], v[254:255], v[126:127]
  s_nop 0
  v_fmac_f32_dpp v124, v252, v156 quad_perm:[1,0,3,2] row_mask:0xf bank_mask:0xf
  v_fmac_f32_dpp v125, v253, v157 quad_perm:[1,0,3,2] row_mask:0xf bank_mask:0xf
  v_fmac_f32_dpp v126, v254, v158 quad_perm:[1,0,3,2] row_mask:0xf bank_mask:0xf
  v_fmac_f32_dpp v127, v255, v159 quad_perm:[1,0,3,2] row_mask:0xf bank_mask:0xf
  v_cvt_pk_bf16_f32 v32, v96, v100
  v_cvt_pk_bf16_f32 v33, v104, v108
  ds_write_b64 v12, v[32:33] offset:12288
  v_cvt_pk_bf16_f32 v34, v97, v101
  v_cvt_pk_bf16_f32 v35, v105, v109
  ds_write_b64 v12, v[34:35] offset:12352
  v_cvt_pk_bf16_f32 v36, v98, v102
  v_cvt_pk_bf16_f32 v37, v106, v110
  ds_write_b64 v12, v[36:37] offset:12416
  v_cvt_pk_bf16_f32 v38, v99, v103
  v_cvt_pk_bf16_f32 v39, v107, v111
  ds_write_b64 v12, v[38:39] offset:12480
  v_cvt_pk_bf16_f32 v40, v112, v116
  v_cvt_pk_bf16_f32 v41, v120, v124
  ds_write_b64 v12, v[40:41] offset:13312
  v_cvt_pk_bf16_f32 v42, v113, v117
  v_cvt_pk_bf16_f32 v43, v121, v125
  ds_write_b64 v12, v[42:43] offset:13376
  v_cvt_pk_bf16_f32 v44, v114, v118
  v_cvt_pk_bf16_f32 v45, v122, v126
  ds_write_b64 v12, v[44:45] offset:13440
  v_cvt_pk_bf16_f32 v46, v115, v119
  v_cvt_pk_bf16_f32 v47, v123, v127
  ds_write_b64 v12, v[46:47] offset:13504
  s_waitcnt lgkmcnt(0)
  s_barrier
  ds_read_b128 v[64:67], v13 offset:12288
  ds_read_b128 v[68:71], v13 offset:13312
  ds_read_b128 v[72:75], v13 offset:14352
  ds_read_b128 v[76:79], v13 offset:15376
  s_waitcnt vmcnt(9)
  v_lshlrev_b32 v80, 16, v184
  v_and_b32 v81, 0xffff0000, v184
  v_lshlrev_b32 v82, 16, v185
  v_and_b32 v83, 0xffff0000, v185
  v_lshlrev_b32 v84, 16, v186
  v_and_b32 v85, 0xffff0000, v186
  v_lshlrev_b32 v86, 16, v187
  v_and_b32 v87, 0xffff0000, v187
  s_waitcnt lgkmcnt(3)
  v_mfma_f32_16x16x32_bf16 v[48:51], v[64:67], a[16:19], 0
  s_waitcnt lgkmcnt(2)
  v_mfma_f32_16x16x32_bf16 v[52:55], v[68:71], a[16:19], 0
  v_lshlrev_b32 v88, 16, v188
  v_and_b32 v89, 0xffff0000, v188
  v_lshlrev_b32 v90, 16, v189
  v_and_b32 v91, 0xffff0000, v189
  v_lshlrev_b32 v92, 16, v190
  v_and_b32 v93, 0xffff0000, v190
  v_lshlrev_b32 v94, 16, v191
  v_and_b32 v95, 0xffff0000, v191
  s_waitcnt lgkmcnt(1)
  v_mfma_f32_16x16x32_bf16 v[56:59], v[72:75], a[16:19], 0
  s_waitcnt lgkmcnt(0)
  v_mfma_f32_16x16x32_bf16 v[60:63], v[76:79], a[16:19], 0
  s_mul_i32 s60, s33, 2080
  v_add_u32 v12, s60, v3
  v_and_b32 v15, 7, v0
  v_mul_u32_u24 v13, 1040, v15
  v_lshlrev_b32 v15, 4, v15
  v_pk_fma_f32 v[80:81], v[160:161], v[48:49], v[80:81]
  v_pk_fma_f32 v[82:83], v[162:163], v[50:51], v[82:83]
  v_pk_fma_f32 v[84:85], v[164:165], v[52:53], v[84:85]
  v_pk_fma_f32 v[86:87], v[166:167], v[54:55], v[86:87]
  v_pk_fma_f32 v[88:89], v[160:161], v[56:57], v[88:89]
  v_pk_fma_f32 v[90:91], v[162:163], v[58:59], v[90:91]
  v_pk_fma_f32 v[92:93], v[164:165], v[60:61], v[92:93]
  v_pk_fma_f32 v[94:95], v[166:167], v[62:63], v[94:95]
  v_pk_add_f32 v[96:97], v[80:81], v[82:83]
  v_pk_mul_f32 v[98:99], v[80:81], v[80:81]
  v_pk_add_f32 v[100:101], v[88:89], v[90:91]
  v_pk_mul_f32 v[102:103], v[88:89], v[88:89]
  v_pk_fma_f32 v[98:99], v[82:83], v[82:83], v[98:99]
  v_pk_fma_f32 v[102:103], v[90:91], v[90:91], v[102:103]
  v_pk_add_f32 v[96:97], v[96:97], v[84:85]
  v_pk_fma_f32 v[98:99], v[84:85], v[84:85], v[98:99]
  v_pk_add_f32 v[100:101], v[100:101], v[92:93]
  v_pk_fma_f32 v[102:103], v[92:93], v[92:93], v[102:103]
  v_pk_add_f32 v[96:97], v[96:97], v[86:87]
  v_pk_fma_f32 v[98:99], v[86:87], v[86:87], v[98:99]
  v_pk_add_f32 v[100:101], v[100:101], v[94:95]
  v_pk_fma_f32 v[102:103], v[94:95], v[94:95], v[102:103]
  v_add_f32 v96, v96, v97
  v_add_f32 v98, v98, v99
  v_add_f32 v100, v100, v101
  v_add_f32 v102, v102, v103
  v_add_f32_dpp v96, v96, v96 quad_perm:[1,0,3,2] row_mask:0xf bank_mask:0xf
  v_add_f32_dpp v98, v98, v98 quad_perm:[1,0,3,2] row_mask:0xf bank_mask:0xf
  v_add_f32_dpp v100, v100, v100 quad_perm:[1,0,3,2] row_mask:0xf bank_mask:0xf
  v_add_f32_dpp v102, v102, v102 quad_perm:[1,0,3,2] row_mask:0xf bank_mask:0xf
  v_add_f32_dpp v96, v96, v96 quad_perm:[2,3,0,1] row_mask:0xf bank_mask:0xf
  v_add_f32_dpp v98, v98, v98 quad_perm:[2,3,0,1] row_mask:0xf bank_mask:0xf
  v_add_f32_dpp v100, v100, v100 quad_perm:[2,3,0,1] row_mask:0xf bank_mask:0xf
  v_add_f32_dpp v102, v102, v102 quad_perm:[2,3,0,1] row_mask:0xf bank_mask:0xf
  v_add_f32_dpp v96, v96, v96 row_half_mirror row_mask:0xf bank_mask:0xf
  v_add_f32_dpp v98, v98, v98 row_half_mirror row_mask:0xf bank_mask:0xf
  v_add_f32_dpp v100, v100, v100 row_half_mirror row_mask:0xf bank_mask:0xf
  v_add_f32_dpp v102, v102, v102 row_half_mirror row_mask:0xf bank_mask:0xf
  v_add_f32_dpp v96, v96, v96 row_mirror row_mask:0xf bank_mask:0xf
  v_add_f32_dpp v98, v98, v98 row_mirror row_mask:0xf bank_mask:0xf
  v_add_f32_dpp v100, v100, v100 row_mirror row_mask:0xf bank_mask:0xf
  v_add_f32_dpp v102, v102, v102 row_mirror row_mask:0xf bank_mask:0xf
  v_add_f32_dpp v96, v96, v96 row_bcast:15 row_mask:0xa bank_mask:0xf
  v_add_f32_dpp v98, v98, v98 row_bcast:15 row_mask:0xa bank_mask:0xf
  v_add_f32_dpp v100, v100, v100 row_bcast:15 row_mask:0xa bank_mask:0xf
  v_add_f32_dpp v102, v102, v102 row_bcast:15 row_mask:0xa bank_mask:0xf
  v_add_f32_dpp v96, v96, v96 row_bcast:31 row_mask:0xc bank_mask:0xf
  v_add_f32_dpp v98, v98, v98 row_bcast:31 row_mask:0xc bank_mask:0xf
  v_add_f32_dpp v100, v100, v100 row_bcast:31 row_mask:0xc bank_mask:0xf
  v_add_f32_dpp v102, v102, v102 row_bcast:31 row_mask:0xc bank_mask:0xf
  v_readlane_b32 s62, v96, 63
  v_readlane_b32 s63, v98, 63
  v_readlane_b32 s64, v100, 63
  v_readlane_b32 s65, v102, 63
  v_cvt_pk_bf16_f32 v104, v80, v81
  v_cvt_pk_bf16_f32 v105, v82, v83
  v_cvt_pk_bf16_f32 v106, v84, v85
  v_cvt_pk_bf16_f32 v107, v86, v87
  v_cvt_pk_bf16_f32 v108, v88, v89
  v_cvt_pk_bf16_f32 v109, v90, v91
  v_cvt_pk_bf16_f32 v110, v92, v93
  v_cvt_pk_bf16_f32 v111, v94, v95
  v_mov_b32 v112, s62
  v_mov_b32 v113, s63
  v_mov_b32 v114, s64
  v_mov_b32 v115, s65
  v_pk_mul_f32 v[112:113], v[112:113], s[72:73] op_sel_hi:[1,0]
  v_pk_mul_f32 v[114:115], v[114:115], s[72:73] op_sel_hi:[1,0]
  v_fma_f32 v113, -v112, v112, v113
  v_fma_f32 v115, -v114, v114, v115
  v_max_f32 v113, 0, v113
  v_max_f32 v115, 0, v115
  v_add_f32 v113, 0x3727c5ac, v113
  v_add_f32 v115, 0x3727c5ac, v115
  v_rsq_f32 v113, v113
  v_rsq_f32 v115, v115
  v_mul_f32 v112, v112, v113
  v_mul_f32 v114, v114, v115
  v_pk_fma_f32 v[80:81], v[80:81], v[112:113], v[112:113] op_sel:[0,1,0] op_sel_hi:[1,1,0] neg_lo:[0,0,1] neg_hi:[0,0,1]
  v_pk_fma_f32 v[82:83], v[82:83], v[112:113], v[112:113] op_sel:[0,1,0] op_sel_hi:[1,1,0] neg_lo:[0,0,1] neg_hi:[0,0,1]
  v_pk_fma_f32 v[84:85], v[84:85], v[112:113], v[112:113] op_sel:[0,1,0] op_sel_hi:[1,1,0] neg_lo:[0,0,1] neg_hi:[0,0,1]
  v_pk_fma_f32 v[86:87], v[86:87], v[112:113], v[112:113] op_sel:[0,1,0] op_sel_hi:[1,1,0] neg_lo:[0,0,1] neg_hi:[0,0,1]
  v_pk_fma_f32 v[88:89], v[88:89], v[114:115], v[114:115] op_sel:[0,1,0] op_sel_hi:[1,1,0] neg_lo:[0,0,1] neg_hi:[0,0,1]
  v_pk_fma_f32 v[90:91], v[90:91], v[114:115], v[114:115] op_sel:[0,1,0] op_sel_hi:[1,1,0] neg_lo:[0,0,1] neg_hi:[0,0,1]
  v_pk_fma_f32 v[92:93], v[92:93], v[114:115], v[114:115] op_sel:[0,1,0] op_sel_hi:[1,1,0] neg_lo:[0,0,1] neg_hi:[0,0,1]
  v_pk_fma_f32 v[94:95], v[94:95], v[114:115], v[114:115] op_sel:[0,1,0] op_sel_hi:[1,1,0] neg_lo:[0,0,1] neg_hi:[0,0,1]
  v_pk_fma_f32 v[80:81], v[80:81], v[168:169], v[176:177]
  v_pk_fma_f32 v[82:83], v[82:83], v[170:171], v[178:179]
  v_pk_fma_f32 v[84:85], v[84:85], v[172:173], v[180:181]
  v_pk_fma_f32 v[86:87], v[86:87], v[174:175], v[182:183]
  v_pk_fma_f32 v[88:89], v[88:89], v[168:169], v[176:177]
  v_pk_fma_f32 v[90:91], v[90:91], v[170:171], v[178:179]
  v_pk_fma_f32 v[92:93], v[92:93], v[172:173], v[180:181]
  v_pk_fma_f32 v[94:95], v[94:95], v[174:175], v[182:183]
  v_cvt_pk_bf16_f32 v116, v80, v81
  v_cvt_pk_bf16_f32 v117, v82, v83
  v_cvt_pk_bf16_f32 v118, v84, v85
  v_cvt_pk_bf16_f32 v119, v86, v87
  ds_write_b128 v12, v[116:119] offset:34816
  v_cvt_pk_bf16_f32 v120, v88, v89
  v_cvt_pk_bf16_f32 v121, v90, v91
  v_cvt_pk_bf16_f32 v122, v92, v93
  v_cvt_pk_bf16_f32 v123, v94, v95
  ds_write_b128 v12, v[120:123] offset:35856
  v_lshrrev_b32 v12, 3, v0
  v_lshl_add_u32 v15, v12, 8, v15
  v_and_b32 v5, 3, v12
  v_lshl_add_u32 v13, v5, 8, v13
  v_lshrrev_b32 v12, 2, v12
  v_lshl_add_u32 v13, v12, 4, v13
  s_lshl_b32 s60, s33, 6
  v_add_u32 v13, s60, v13
  s_lshl_b32 s60, s34, 17
  s_lshr_b32 s61, s35, 1
  s_lshl_b32 s61, s61, 14
  s_add_u32 s60, s60, s61
  s_and_b32 s61, s35, 1
  s_lshl_b32 s61, s61, 7
  s_add_u32 s60, s60, s61
  s_lshl_b32 s61, s33, 12
  s_add_u32 s60, s60, s61
  s_add_u32 s60, s60, 2097152
  s_waitcnt vmcnt(8)
  v_accvgpr_read_b32 v6, a20
  v_xor_b32 v6, s101, v6
  v_cmp_ne_u32 vcc, s82, v6
  s_nop 4
  s_cmp_eq_u64 vcc, 0
  s_cselect_b32 s83, 1, 0
  s_waitcnt lgkmcnt(0)
  s_barrier
  ds_read_b128 v[120:123], v13 offset:34816
  ds_read_b128 v[124:127], v13 offset:34848
  s_waitcnt lgkmcnt(0)
  s_cmp_eq_u32 s83, 1
  s_cbranch_scc0 adaLN_cond__spectral_fnet__dense_activation_relu__prompt_kernel_h2_slow
  buffer_store_dwordx4 v[120:123], v15, s[8:11], s60 offen offset:0
  buffer_store_dwordx4 v[124:127], v15, s[8:11], s60 offen offset:2048
  s_branch adaLN_cond__spectral_fnet__dense_activation_relu__prompt_kernel_h2_done
adaLN_cond__spectral_fnet__dense_activation_relu__prompt_kernel_h2_slow:
  buffer_store_dwordx4 v[120:123], v15, s[8:11], s60 offen offset:0 sc1
  buffer_store_dwordx4 v[124:127], v15, s[8:11], s60 offen offset:2048 sc1
adaLN_cond__spectral_fnet__dense_activation_relu__prompt_kernel_h2_done:
  s_lshl_b32 s60, s34, 11
  s_lshl_b32 s61, s35, 7
  s_add_u32 s60, s60, s61
  s_add_u32 s60, s60, 8552448
  v_mov_b32 v5, s101
  v_mov_b32 v6, 0
  s_waitcnt vmcnt(0)
  s_barrier
  s_cmp_lg_u32 s33, 0
  s_cbranch_scc1 adaLN_cond__spectral_fnet__dense_activation_relu__prompt_kernel_pb_nf
  s_mov_b64 exec, 1
  s_cmp_eq_u32 s83, 1
  s_cbranch_scc0 adaLN_cond__spectral_fnet__dense_activation_relu__prompt_kernel_pb_fs
  buffer_store_dword v5, v6, s[8:11], s60 offen
  s_branch adaLN_cond__spectral_fnet__dense_activation_relu__prompt_kernel_pb_fd
adaLN_cond__spectral_fnet__dense_activation_relu__prompt_kernel_pb_fs:
  buffer_store_dword v5, v6, s[8:11], s60 offen sc1
adaLN_cond__spectral_fnet__dense_activation_relu__prompt_kernel_pb_fd:
  s_mov_b64 exec, -1
adaLN_cond__spectral_fnet__dense_activation_relu__prompt_kernel_pb_nf:
  s_cmp_eq_u32 s83, 1
  s_cbranch_scc0 adaLN_cond__spectral_fnet__dense_activation_relu__prompt_kernel_x2_slow
  buffer_store_dwordx2 v[104:105], v14, s[20:23], s58 offen offset:0
  buffer_store_dwordx2 v[106:107], v14, s[20:23], s58 offen offset:32
  buffer_store_dwordx2 v[108:109], v14, s[20:23], s59 offen offset:0
  buffer_store_dwordx2 v[110:111], v14, s[20:23], s59 offen offset:32
  s_branch adaLN_cond__spectral_fnet__dense_activation_relu__prompt_kernel_x2_done
adaLN_cond__spectral_fnet__dense_activation_relu__prompt_kernel_x2_slow:
  buffer_store_dwordx2 v[104:105], v14, s[20:23], s58 offen offset:0 sc1
  buffer_store_dwordx2 v[106:107], v14, s[20:23], s58 offen offset:32 sc1
  buffer_store_dwordx2 v[108:109], v14, s[20:23], s59 offen offset:0 sc1
  buffer_store_dwordx2 v[110:111], v14, s[20:23], s59 offen offset:32 sc1
adaLN_cond__spectral_fnet__dense_activation_relu__prompt_kernel_x2_done:
  s_and_b32 s76, s35, 7
  s_lshl_b32 s76, s76, 2
  s_add_u32 s76, s76, s33
  s_mul_i32 s76, s76, 57344
  s_add_u32 s76, s76, 6291456
  s_and_b32 s77, s34, 1
  s_lshl_b32 s77, s77, 1
  s_lshr_b32 s78, s35, 3
  s_add_u32 s77, s77, s78
  s_mul_i32 s77, s77, 7
  s_add_u32 s77, s77, 1
  s_lshr_b32 s77, s77, 1
  s_mov_b32 s79, s77
  s_lshl_b32 s77, s77, 12
  s_mov_b32 s75, s77
  s_cmp_eq_u32 s33, 0
  s_cbranch_scc1 adaLN_cond__spectral_fnet__dense_activation_relu__prompt_kernel_now2
  s_add_u32 s78, s76, s77
  buffer_load_dwordx4 a[0:3], v3, s[8:11], s78 offen offset:0 sc1
  buffer_load_dwordx4 a[4:7], v3, s[8:11], s78 offen offset:1024 sc1
  buffer_load_dwordx4 a[8:11], v3, s[8:11], s78 offen offset:2048 sc1
  buffer_load_dwordx4 a[12:15], v3, s[8:11], s78 offen offset:3072 sc1
  s_add_u32 s77, s77, 4096
  s_cmp_eq_u32 s77, 57344
  s_cselect_b32 s77, 0, s77
  s_add_u32 s78, s76, s77
  buffer_load_dwordx4 a[16:19], v3, s[8:11], s78 offen offset:0 sc1
  buffer_load_dwordx4 a[20:23], v3, s[8:11], s78 offen offset:1024 sc1
  buffer_load_dwordx4 a[24:27], v3, s[8:11], s78 offen offset:2048 sc1
  buffer_load_dwordx4 a[28:31], v3, s[8:11], s78 offen offset:3072 sc1
  s_add_u32 s77, s77, 4096
  s_cmp_eq_u32 s77, 57344
  s_cselect_b32 s77, 0, s77
adaLN_cond__spectral_fnet__dense_activation_relu__prompt_kernel_now2:
  s_cmp_lg_u32 s33, 0
  s_cbranch_scc1 adaLN_cond__spectral_fnet__dense_activation_relu__prompt_kernel_qb_pd
  s_lshl_b32 s60, s34, 11
  v_lshlrev_b32 v6, 7, v2
  s_add_u32 s60, s60, 8552448
  s_mov_b32 s61, 65536
adaLN_cond__spectral_fnet__dense_activation_relu__prompt_kernel_qb_pl:
  buffer_load_dword v5, v6, s[8:11], s60 offen sc1
  s_sub_u32 s61, s61, 1
  s_waitcnt vmcnt(0)
  v_cmp_ne_u32 vcc, s101, v5
  s_cmp_eq_u32 s61, 0
  s_cbranch_scc1 adaLN_cond__spectral_fnet__dense_activation_relu__prompt_kernel_qb_pd
  s_cbranch_vccnz adaLN_cond__spectral_fnet__dense_activation_relu__prompt_kernel_qb_pl
adaLN_cond__spectral_fnet__dense_activation_relu__prompt_kernel_qb_pd:
  s_barrier
  s_lshl_b32 s72, s34, 17
  s_lshl_b32 s73, s33, 15
  s_add_u32 s72, s72, s73
  s_add_u32 s72, s72, 2097152
  s_add_u32 s73, s72, 16384
  buffer_load_dwordx4 v[128:131], v3, s[8:11], s72 offen offset:0 sc1
  buffer_load_dwordx4 v[132:135], v3, s[8:11], s73 offen offset:0 sc1
  buffer_load_dwordx4 v[136:139], v3, s[8:11], s72 offen offset:1024 sc1
  buffer_load_dwordx4 v[140:143], v3, s[8:11], s73 offen offset:1024 sc1
  buffer_load_dwordx4 v[144:147], v3, s[8:11], s72 offen offset:2048 sc1
  buffer_load_dwordx4 v[148:151], v3, s[8:11], s73 offen offset:2048 sc1
  buffer_load_dwordx4 v[152:155], v3, s[8:11], s72 offen offset:3072 sc1
  buffer_load_dwordx4 v[156:159], v3, s[8:11], s73 offen offset:3072 sc1
  s_add_u32 s72, s72, 4096
  buffer_load_dwordx4 v[160:163], v3, s[8:11], s72 offen offset:0 sc1
  s_add_u32 s73, s73, 4096
  buffer_load_dwordx4 v[164:167], v3, s[8:11], s73 offen offset:0 sc1
  s_cmp_lg_u32 s33, 0
  s_cbranch_scc1 adaLN_cond__spectral_fnet__dense_activation_relu__prompt_kernel_now2b
  s_mov_b32 s77, s75
  s_add_u32 s78, s76, s77
  buffer_load_dwordx4 a[0:3], v3, s[8:11], s78 offen offset:0 sc1
  buffer_load_dwordx4 a[4:7], v3, s[8:11], s78 offen offset:1024 sc1
  buffer_load_dwordx4 a[8:11], v3, s[8:11], s78 offen offset:2048 sc1
  buffer_load_dwordx4 a[12:15], v3, s[8:11], s78 offen offset:3072 sc1
  s_add_u32 s77, s77, 4096
  s_cmp_eq_u32 s77, 57344
  s_cselect_b32 s77, 0, s77
  s_add_u32 s78, s76, s77
  buffer_load_dwordx4 a[16:19], v3, s[8:11], s78 offen offset:0 sc1
  buffer_load_dwordx4 a[20:23], v3, s[8:11], s78 offen offset:1024 sc1
  buffer_load_dwordx4 a[24:27], v3, s[8:11], s78 offen offset:2048 sc1
  buffer_load_dwordx4 a[28:31], v3, s[8:11], s78 offen offset:3072 sc1
  s_add_u32 s77, s77, 4096
  s_cmp_eq_u32 s77, 57344
  s_cselect_b32 s77, 0, s77
adaLN_cond__spectral_fnet__dense_activation_relu__prompt_kernel_now2b:
  v_lshrrev_b32 v4, 2, v2
  v_lshl_add_u32 v4, v1, 2, v4
  v_mul_u32_u24 v4, 224, v4
  v_and_b32 v5, 3, v2
  v_lshl_add_u32 v4, v5, 3, v4
  v_add_u32 v4, 49152, v4
  v_add_u32 v5, 57344, v4
  ds_read_b64_tr_b16 v[8:9], v4 offset:0
  ds_read_b64_tr_b16 v[10:11], v4 offset:3584
  ds_read_b64_tr_b16 v[12:13], v4 offset:32
  ds_read_b64_tr_b16 v[14:15], v4 offset:3616
  ds_read_b64_tr_b16 v[16:17], v4 offset:64
  ds_read_b64_tr_b16 v[18:19], v4 offset:3648
  ds_read_b64_tr_b16 v[20:21], v4 offset:96
  ds_read_b64_tr_b16 v[22:23], v4 offset:3680
  ds_read_b64_tr_b16 v[24:25], v4 offset:128
  ds_read_b64_tr_b16 v[26:27], v4 offset:3712
  ds_read_b64_tr_b16 v[28:29], v4 offset:160
  ds_read_b64_tr_b16 v[30:31], v4 offset:3744
  ds_read_b64_tr_b16 v[32:33], v4 offset:192
  ds_read_b64_tr_b16 v[34:35], v4 offset:3776
  s_waitcnt lgkmcnt(12)
  s_waitcnt vmcnt(9)
  v_mfma_f32_16x16x32_bf16 v[64:67], v[8:11], v[128:131], 0
  ds_read_b64_tr_b16 v[36:37], v4 offset:7168
  s_waitcnt vmcnt(8)
  v_mfma_f32_16x16x32_bf16 v[68:71], v[8:11], v[132:135], 0
  ds_read_b64_tr_b16 v[38:39], v4 offset:10752
  s_waitcnt lgkmcnt(12)
  v_mfma_f32_16x16x32_bf16 v[72:75], v[12:15], v[128:131], 0
  ds_read_b64_tr_b16 v[40:41], v4 offset:7200
  v_mfma_f32_16x16x32_bf16 v[76:79], v[12:15], v[132:135], 0
  ds_read_b64_tr_b16 v[42:43], v4 offset:10784
  s_waitcnt lgkmcnt(12)
  v_mfma_f32_16x16x32_bf16 v[80:83], v[16:19], v[128:131], 0
  ds_read_b64_tr_b16 v[44:45], v4 offset:7232
  v_mfma_f32_16x16x32_bf16 v[84:87], v[16:19], v[132:135], 0
  ds_read_b64_tr_b16 v[46:47], v4 offset:10816
  buffer_load_dwordx4 v[168:171], v3, s[8:11], s72 offen offset:1024 sc1
  s_waitcnt lgkmcnt(12)
  v_mfma_f32_16x16x32_bf16 v[88:91], v[20:23], v[128:131], 0
  ds_read_b64_tr_b16 v[48:49], v4 offset:7264
  v_mfma_f32_16x16x32_bf16 v[92:95], v[20:23], v[132:135], 0
  ds_read_b64_tr_b16 v[50:51], v4 offset:10848
  s_waitcnt lgkmcnt(12)
  v_mfma_f32_16x16x32_bf16 v[96:99], v[24:27], v[128:131], 0
  ds_read_b64_tr_b16 v[52:53], v4 offset:7296
  v_mfma_f32_16x16x32_bf16 v[100:103], v[24:27], v[132:135], 0
  ds_read_b64_tr_b16 v[54:55], v4 offset:10880
  buffer_load_dwordx4 v[172:175], v3, s[8:11], s73 offen offset:1024 sc1
  s_waitcnt lgkmcnt(12)
  v_mfma_f32_16x16x32_bf16 v[104:107], v[28:31], v[128:131], 0
  ds_read_b64_tr_b16 v[56:57], v4 offset:7328
  v_mfma_f32_16x16x32_bf16 v[108:111], v[28:31], v[132:135], 0
  ds_read_b64_tr_b16 v[58:59], v4 offset:10912
  s_waitcnt lgkmcnt(12)
  v_mfma_f32_16x16x32_bf16 v[112:115], v[32:35], v[128:131], 0
  ds_read_b64_tr_b16 v[60:61], v4 offset:7360
  v_mfma_f32_16x16x32_bf16 v[116:119], v[32:35], v[132:135], 0
  ds_read_b64_tr_b16 v[62:63], v4 offset:10944
  buffer_load_dwordx4 v[176:179], v3, s[8:11], s72 offen offset:2048 sc1
  s_waitcnt lgkmcnt(12)
  s_waitcnt vmcnt(10)
  v_mfma_f32_16x16x32_bf16 v[64:67], v[36:39], v[136:139], v[64:67]
  ds_read_b64_tr_b16 v[8:9], v4 offset:14336
  s_waitcnt vmcnt(9)
  v_mfma_f32_16x16x32_bf16 v[68:71], v[36:39], v[140:143], v[68:71]
  ds_read_b64_tr_b16 v[10:11], v4 offset:17920
  s_waitcnt lgkmcnt(12)
  v_mfma_f32_16x16x32_bf16 v[72:75], v[40:43], v[136:139], v[72:75]
  ds_read_b64_tr_b16 v[12:13], v4 offset:14368
  v_mfma_f32_16x16x32_bf16 v[76:79], v[40:43], v[140:143], v[76:79]
  ds_read_b64_tr_b16 v[14:15], v4 offset:17952
  buffer_load_dwordx4 v[180:183], v3, s[8:11], s73 offen offset:2048 sc1
  s_waitcnt lgkmcnt(12)
  v_mfma_f32_16x16x32_bf16 v[80:83], v[44:47], v[136:139], v[80:83]
  ds_read_b64_tr_b16 v[16:17], v4 offset:14400
  v_mfma_f32_16x16x32_bf16 v[84:87], v[44:47], v[140:143], v[84:87]
  ds_read_b64_tr_b16 v[18:19], v4 offset:17984
  s_waitcnt lgkmcnt(12)
  v_mfma_f32_16x16x32_bf16 v[88:91], v[48:51], v[136:139], v[88:91]
  ds_read_b64_tr_b16 v[20:21], v4 offset:14432
  v_mfma_f32_16x16x32_bf16 v[92:95], v[48:51], v[140:143], v[92:95]
  ds_read_b64_tr_b16 v[22:23], v4 offset:18016
  buffer_load_dwordx4 v[184:187], v3, s[8:11], s72 offen offset:3072 sc1
  s_waitcnt lgkmcnt(12)
  v_mfma_f32_16x16x32_bf16 v[96:99], v[52:55], v[136:139], v[96:99]
  ds_read_b64_tr_b16 v[24:25], v4 offset:14464
  v_mfma_f32_16x16x32_bf16 v[100:103], v[52:55], v[140:143], v[100:103]
  ds_read_b64_tr_b16 v[26:27], v4 offset:18048
  s_waitcnt lgkmcnt(12)
  v_mfma_f32_16x16x32_bf16 v[104:107], v[56:59], v[136:139], v[104:107]
  ds_read_b64_tr_b16 v[28:29], v4 offset:14496
  v_mfma_f32_16x16x32_bf16 v[108:111], v[56:59], v[140:143], v[108:111]
  ds_read_b64_tr_b16 v[30:31], v4 offset:18080
  s_waitcnt lgkmcnt(12)
  v_mfma_f32_16x16x32_bf16 v[112:115], v[60:63], v[136:139], v[112:115]
  ds_read_b64_tr_b16 v[32:33], v4 offset:14528
  v_mfma_f32_16x16x32_bf16 v[116:119], v[60:63], v[140:143], v[116:119]
  ds_read_b64_tr_b16 v[34:35], v4 offset:18112
  buffer_load_dwordx4 v[188:191], v3, s[8:11], s73 offen offset:3072 sc1
  s_waitcnt lgkmcnt(12)
  s_waitcnt vmcnt(11)
  v_mfma_f32_16x16x32_bf16 v[64:67], v[8:11], v[144:147], v[64:67]
  ds_read_b64_tr_b16 v[36:37], v4 offset:21504
  s_waitcnt vmcnt(10)
  v_mfma_f32_16x16x32_bf16 v[68:71], v[8:11], v[148:151], v[68:71]
  ds_read_b64_tr_b16 v[38:39], v4 offset:25088
  s_waitcnt lgkmcnt(12)
  v_mfma_f32_16x16x32_bf16 v[72:75], v[12:15], v[144:147], v[72:75]
  ds_read_b64_tr_b16 v[40:41], v4 offset:21536
  v_mfma_f32_16x16x32_bf16 v[76:79], v[12:15], v[148:151], v[76:79]
  ds_read_b64_tr_b16 v[42:43], v4 offset:25120
  s_add_u32 s72, s72, 4096
  buffer_load_dwordx4 v[192:195], v3, s[8:11], s72 offen offset:0 sc1
  s_waitcnt lgkmcnt(12)
  v_mfma_f32_16x16x32_bf16 v[80:83], v[16:19], v[144:147], v[80:83]
  ds_read_b64_tr_b16 v[44:45], v4 offset:21568
  v_mfma_f32_16x16x32_bf16 v[84:87], v[16:19], v[148:151], v[84:87]
  ds_read_b64_tr_b16 v[46:47], v4 offset:25152
  s_waitcnt lgkmcnt(12)
  v_mfma_f32_16x16x32_bf16 v[88:91], v[20:23], v[144:147], v[88:91]
  ds_read_b64_tr_b16 v[48:49], v4 offset:21600
  v_mfma_f32_16x16x32_bf16 v[92:95], v[20:23], v[148:151], v[92:95]
  ds_read_b64_tr_b16 v[50:51], v4 offset:25184
  s_add_u32 s73, s73, 4096
  buffer_load_dwordx4 v[196:199], v3, s[8:11], s73 offen offset:0 sc1
  s_waitcnt lgkmcnt(12)
  v_mfma_f32_16x16x32_bf16 v[96:99], v[24:27], v[144:147], v[96:99]
  ds_read_b64_tr_b16 v[52:53], v4 offset:21632
  v_mfma_f32_16x16x32_bf16 v[100:103], v[24:27], v[148:151], v[100:103]
  ds_read_b64_tr_b16 v[54:55], v4 offset:25216
  s_waitcnt lgkmcnt(12)
  v_mfma_f32_16x16x32_bf16 v[104:107], v[28:31], v[144:147], v[104:107]
  ds_read_b64_tr_b16 v[56:57], v4 offset:21664
  v_mfma_f32_16x16x32_bf16 v[108:111], v[28:31], v[148:151], v[108:111]
  ds_read_b64_tr_b16 v[58:59], v4 offset:25248
  buffer_load_dwordx4 v[200:203], v3, s[8:11], s72 offen offset:1024 sc1
  s_waitcnt lgkmcnt(12)
  v_mfma_f32_16x16x32_bf16 v[112:115], v[32:35], v[144:147], v[112:115]
  ds_read_b64_tr_b16 v[60:61], v4 offset:21696
  v_mfma_f32_16x16x32_bf16 v[116:119], v[32:35], v[148:151], v[116:119]
  ds_read_b64_tr_b16 v[62:63], v4 offset:25280
  s_waitcnt lgkmcnt(12)
  s_waitcnt vmcnt(12)
  v_mfma_f32_16x16x32_bf16 v[64:67], v[36:39], v[152:155], v[64:67]
  ds_read_b64_tr_b16 v[8:9], v4 offset:28672
  s_waitcnt vmcnt(11)
  v_mfma_f32_16x16x32_bf16 v[68:71], v[36:39], v[156:159], v[68:71]
  ds_read_b64_tr_b16 v[10:11], v4 offset:32256
  buffer_load_dwordx4 v[204:207], v3, s[8:11], s73 offen offset:1024 sc1
  s_waitcnt lgkmcnt(12)
  v_mfma_f32_16x16x32_bf16 v[72:75], v[40:43], v[152:155], v[72:75]
  ds_read_b64_tr_b16 v[12:13], v4 offset:28704
  v_mfma_f32_16x16x32_bf16 v[76:79], v[40:43], v[156:159], v[76:79]
  ds_read_b64_tr_b16 v[14:15], v4 offset:32288
  s_waitcnt lgkmcnt(12)
  v_mfma_f32_16x16x32_bf16 v[80:83], v[44:47], v[152:155], v[80:83]
  ds_read_b64_tr_b16 v[16:17], v4 offset:28736
  v_mfma_f32_16x16x32_bf16 v[84:87], v[44:47], v[156:159], v[84:87]
  ds_read_b64_tr_b16 v[18:19], v4 offset:32320
  s_waitcnt lgkmcnt(12)
  v_mfma_f32_16x16x32_bf16 v[88:91], v[48:51], v[152:155], v[88:91]
  ds_read_b64_tr_b16 v[20:21], v4 offset:28768
  v_mfma_f32_16x16x32_bf16 v[92:95], v[48:51], v[156:159], v[92:95]
  ds_read_b64_tr_b16 v[22:23], v4 offset:32352
  buffer_load_dwordx4 v[208:211], v3, s[8:11], s72 offen offset:2048 sc1
  s_waitcnt lgkmcnt(12)
  v_mfma_f32_16x16x32_bf16 v[96:99], v[52:55], v[152:155], v[96:99]
  ds_read_b64_tr_b16 v[24:25], v4 offset:28800
  v_mfma_f32_16x16x32_bf16 v[100:103], v[52:55], v[156:159], v[100:103]
  ds_read_b64_tr_b16 v[26:27], v4 offset:32384
  s_waitcnt lgkmcnt(12)
  v_mfma_f32_16x16x32_bf16 v[104:107], v[56:59], v[152:155], v[104:107]
  ds_read_b64_tr_b16 v[28:29], v4 offset:28832
  v_mfma_f32_16x16x32_bf16 v[108:111], v[56:59], v[156:159], v[108:111]
  ds_read_b64_tr_b16 v[30:31], v4 offset:32416
  buffer_load_dwordx4 v[212:215], v3, s[8:11], s73 offen offset:2048 sc1
  s_waitcnt lgkmcnt(12)
  v_mfma_f32_16x16x32_bf16 v[112:115], v[60:63], v[152:155], v[112:115]
  ds_read_b64_tr_b16 v[32:33], v4 offset:28864
  v_mfma_f32_16x16x32_bf16 v[116:119], v[60:63], v[156:159], v[116:119]
  ds_read_b64_tr_b16 v[34:35], v4 offset:32448
  s_waitcnt lgkmcnt(12)
  s_waitcnt vmcnt(13)
  v_mfma_f32_16x16x32_bf16 v[64:67], v[8:11], v[160:163], v[64:67]
  ds_read_b64_tr_b16 v[36:37], v4 offset:35840
  s_waitcnt vmcnt(12)
  v_mfma_f32_16x16x32_bf16 v[68:71], v[8:11], v[164:167], v[68:71]
  ds_read_b64_tr_b16 v[38:39], v4 offset:39424
  buffer_load_dwordx4 v[216:219], v3, s[8:11], s72 offen offset:3072 sc1
  s_waitcnt lgkmcnt(12)
  v_mfma_f32_16x16x32_bf16 v[72:75], v[12:15], v[160:163], v[72:75]
  ds_read_b64_tr_b16 v[40:41], v4 offset:35872
  v_mfma_f32_16x16x32_bf16 v[76:79], v[12:15], v[164:167], v[76:79]
  ds_read_b64_tr_b16 v[42:43], v4 offset:39456
  s_waitcnt lgkmcnt(12)
  v_mfma_f32_16x16x32_bf16 v[80:83], v[16:19], v[160:163], v[80:83]
  ds_read_b64_tr_b16 v[44:45], v4 offset:35904
  v_mfma_f32_16x16x32_bf16 v[84:87], v[16:19], v[164:167], v[84:87]
  ds_read_b64_tr_b16 v[46:47], v4 offset:39488
  buffer_load_dwordx4 v[220:223], v3, s[8:11], s73 offen offset:3072 sc1
  s_waitcnt lgkmcnt(12)
  v_mfma_f32_16x16x32_bf16 v[88:91], v[20:23], v[160:163], v[88:91]
  ds_read_b64_tr_b16 v[48:49], v4 offset:35936
  v_mfma_f32_16x16x32_bf16 v[92:95], v[20:23], v[164:167], v[92:95]
  ds_read_b64_tr_b16 v[50:51], v4 offset:39520
  s_waitcnt lgkmcnt(12)
  v_mfma_f32_16x16x32_bf16 v[96:99], v[24:27], v[160:163], v[96:99]
  ds_read_b64_tr_b16 v[52:53], v4 offset:35968
  v_mfma_f32_16x16x32_bf16 v[100:103], v[24:27], v[164:167], v[100:103]
  ds_read_b64_tr_b16 v[54:55], v4 offset:39552
  s_add_u32 s72, s72, 4096
  buffer_load_dwordx4 v[224:227], v3, s[8:11], s72 offen offset:0 sc1
  s_waitcnt lgkmcnt(12)
  v_mfma_f32_16x16x32_bf16 v[104:107], v[28:31], v[160:163], v[104:107]
  ds_read_b64_tr_b16 v[56:57], v4 offset:36000
  v_mfma_f32_16x16x32_bf16 v[108:111], v[28:31], v[164:167], v[108:111]
  ds_read_b64_tr_b16 v[58:59], v4 offset:39584
  s_waitcnt lgkmcnt(12)
  v_mfma_f32_16x16x32_bf16 v[112:115], v[32:35], v[160:163], v[112:115]
  ds_read_b64_tr_b16 v[60:61], v4 offset:36032
  v_mfma_f32_16x16x32_bf16 v[116:119], v[32:35], v[164:167], v[116:119]
  ds_read_b64_tr_b16 v[62:63], v4 offset:39616
  s_waitcnt lgkmcnt(12)
  s_waitcnt vmcnt(14)
  v_mfma_f32_16x16x32_bf16 v[64:67], v[36:39], v[168:171], v[64:67]
  ds_read_b64_tr_b16 v[8:9], v4 offset:43008
  s_waitcnt vmcnt(13)
  v_mfma_f32_16x16x32_bf16 v[68:71], v[36:39], v[172:175], v[68:71]
  ds_read_b64_tr_b16 v[10:11], v4 offset:46592
  s_add_u32 s73, s73, 4096
  buffer_load_dwordx4 v[228:231], v3, s[8:11], s73 offen offset:0 sc1
  s_waitcnt lgkmcnt(12)
  v_mfma_f32_16x16x32_bf16 v[72:75], v[40:43], v[168:171], v[72:75]
  ds_read_b64_tr_b16 v[12:13], v4 offset:43040
  v_mfma_f32_16x16x32_bf16 v[76:79], v[40:43], v[172:175], v[76:79]
  ds_read_b64_tr_b16 v[14:15], v4 offset:46624
  s_waitcnt lgkmcnt(12)
  v_mfma_f32_16x16x32_bf16 v[80:83], v[44:47], v[168:171], v[80:83]
  ds_read_b64_tr_b16 v[16:17], v4 offset:43072
  v_mfma_f32_16x16x32_bf16 v[84:87], v[44:47], v[172:175], v[84:87]
  ds_read_b64_tr_b16 v[18:19], v4 offset:46656
  buffer_load_dwordx4 v[232:235], v3, s[8:11], s72 offen offset:1024 sc1
  s_waitcnt lgkmcnt(12)
  v_mfma_f32_16x16x32_bf16 v[88:91], v[48:51], v[168:171], v[88:91]
  ds_read_b64_tr_b16 v[20:21], v4 offset:43104
  v_mfma_f32_16x16x32_bf16 v[92:95], v[48:51], v[172:175], v[92:95]
  ds_read_b64_tr_b16 v[22:23], v4 offset:46688
  s_waitcnt lgkmcnt(12)
  v_mfma_f32_16x16x32_bf16 v[96:99], v[52:55], v[168:171], v[96:99]
  ds_read_b64_tr_b16 v[24:25], v4 offset:43136
  v_mfma_f32_16x16x32_bf16 v[100:103], v[52:55], v[172:175], v[100:103]
  ds_read_b64_tr_b16 v[26:27], v4 offset:46720
  buffer_load_dwordx4 v[236:239], v3, s[8:11], s73 offen offset:1024 sc1
  s_waitcnt lgkmcnt(12)
  v_mfma_f32_16x16x32_bf16 v[104:107], v[56:59], v[168:171], v[104:107]
  ds_read_b64_tr_b16 v[28:29], v4 offset:43168
  v_mfma_f32_16x16x32_bf16 v[108:111], v[56:59], v[172:175], v[108:111]
  ds_read_b64_tr_b16 v[30:31], v4 offset:46752
  s_waitcnt lgkmcnt(12)
  v_mfma_f32_16x16x32_bf16 v[112:115], v[60:63], v[168:171], v[112:115]
  ds_read_b64_tr_b16 v[32:33], v4 offset:43200
  v_mfma_f32_16x16x32_bf16 v[116:119], v[60:63], v[172:175], v[116:119]
  ds_read_b64_tr_b16 v[34:35], v4 offset:46784
  buffer_load_dwordx4 v[240:243], v3, s[8:11], s72 offen offset:2048 sc1
  s_waitcnt lgkmcnt(12)
  s_waitcnt vmcnt(16)
  v_mfma_f32_16x16x32_bf16 v[64:67], v[8:11], v[176:179], v[64:67]
  ds_read_b64_tr_b16 v[36:37], v4 offset:50176
  s_waitcnt vmcnt(15)
  v_mfma_f32_16x16x32_bf16 v[68:71], v[8:11], v[180:183], v[68:71]
  ds_read_b64_tr_b16 v[38:39], v4 offset:53760
  s_waitcnt lgkmcnt(12)
  v_mfma_f32_16x16x32_bf16 v[72:75], v[12:15], v[176:179], v[72:75]
  ds_read_b64_tr_b16 v[40:41], v4 offset:50208
  v_mfma_f32_16x16x32_bf16 v[76:79], v[12:15], v[180:183], v[76:79]
  ds_read_b64_tr_b16 v[42:43], v4 offset:53792
  buffer_load_dwordx4 v[244:247], v3, s[8:11], s73 offen offset:2048 sc1
  s_waitcnt lgkmcnt(12)
  v_mfma_f32_16x16x32_bf16 v[80:83], v[16:19], v[176:179], v[80:83]
  ds_read_b64_tr_b16 v[44:45], v4 offset:50240
  v_mfma_f32_16x16x32_bf16 v[84:87], v[16:19], v[180:183], v[84:87]
  ds_read_b64_tr_b16 v[46:47], v4 offset:53824
  s_waitcnt lgkmcnt(12)
  v_mfma_f32_16x16x32_bf16 v[88:91], v[20:23], v[176:179], v[88:91]
  ds_read_b64_tr_b16 v[48:49], v4 offset:50272
  v_mfma_f32_16x16x32_bf16 v[92:95], v[20:23], v[180:183], v[92:95]
  ds_read_b64_tr_b16 v[50:51], v4 offset:53856
  s_waitcnt lgkmcnt(12)
  v_mfma_f32_16x16x32_bf16 v[96:99], v[24:27], v[176:179], v[96:99]
  ds_read_b64_tr_b16 v[52:53], v4 offset:50304
  v_mfma_f32_16x16x32_bf16 v[100:103], v[24:27], v[180:183], v[100:103]
  ds_read_b64_tr_b16 v[54:55], v4 offset:53888
  buffer_load_dwordx4 v[248:251], v3, s[8:11], s72 offen offset:3072 sc1
  s_waitcnt lgkmcnt(12)
  v_mfma_f32_16x16x32_bf16 v[104:107], v[28:31], v[176:179], v[104:107]
  ds_read_b64_tr_b16 v[56:57], v4 offset:50336
  v_mfma_f32_16x16x32_bf16 v[108:111], v[28:31], v[180:183], v[108:111]
  ds_read_b64_tr_b16 v[58:59], v4 offset:53920
  s_waitcnt lgkmcnt(12)
  v_mfma_f32_16x16x32_bf16 v[112:115], v[32:35], v[176:179], v[112:115]
  ds_read_b64_tr_b16 v[60:61], v4 offset:50368
  v_mfma_f32_16x16x32_bf16 v[116:119], v[32:35], v[180:183], v[116:119]
  ds_read_b64_tr_b16 v[62:63], v4 offset:53952
  buffer_load_dwordx4 v[252:255], v3, s[8:11], s73 offen offset:3072 sc1
  s_waitcnt lgkmcnt(12)
  s_waitcnt vmcnt(17)
  v_mfma_f32_16x16x32_bf16 v[64:67], v[36:39], v[184:187], v[64:67]
  ds_read_b64_tr_b16 v[8:9], v5 offset:0
  s_waitcnt vmcnt(16)
  v_mfma_f32_16x16x32_bf16 v[68:71], v[36:39], v[188:191], v[68:71]
  ds_read_b64_tr_b16 v[10:11], v5 offset:3584
  s_waitcnt lgkmcnt(12)
  v_mfma_f32_16x16x32_bf16 v[72:75], v[40:43], v[184:187], v[72:75]
  ds_read_b64_tr_b16 v[12:13], v5 offset:32
  v_mfma_f32_16x16x32_bf16 v[76:79], v[40:43], v[188:191], v[76:79]
  ds_read_b64_tr_b16 v[14:15], v5 offset:3616
  s_add_u32 s78, s76, s77
  buffer_load_dwordx4 a[32:35], v3, s[8:11], s78 offen offset:0 sc1
  s_waitcnt lgkmcnt(12)
  v_mfma_f32_16x16x32_bf16 v[80:83], v[44:47], v[184:187], v[80:83]
  ds_read_b64_tr_b16 v[16:17], v5 offset:64
  v_mfma_f32_16x16x32_bf16 v[84:87], v[44:47], v[188:191], v[84:87]
  ds_read_b64_tr_b16 v[18:19], v5 offset:3648
  s_waitcnt lgkmcnt(12)
  v_mfma_f32_16x16x32_bf16 v[88:91], v[48:51], v[184:187], v[88:91]
  ds_read_b64_tr_b16 v[20:21], v5 offset:96
  v_mfma_f32_16x16x32_bf16 v[92:95], v[48:51], v[188:191], v[92:95]
  ds_read_b64_tr_b16 v[22:23], v5 offset:3680
  buffer_load_dwordx4 a[36:39], v3, s[8:11], s78 offen offset:1024 sc1
  s_waitcnt lgkmcnt(12)
  v_mfma_f32_16x16x32_bf16 v[96:99], v[52:55], v[184:187], v[96:99]
  ds_read_b64_tr_b16 v[24:25], v5 offset:128
  v_mfma_f32_16x16x32_bf16 v[100:103], v[52:55], v[188:191], v[100:103]
  ds_read_b64_tr_b16 v[26:27], v5 offset:3712
  s_waitcnt lgkmcnt(12)
  v_mfma_f32_16x16x32_bf16 v[104:107], v[56:59], v[184:187], v[104:107]
  ds_read_b64_tr_b16 v[28:29], v5 offset:160
  v_mfma_f32_16x16x32_bf16 v[108:111], v[56:59], v[188:191], v[108:111]
  ds_read_b64_tr_b16 v[30:31], v5 offset:3744
  buffer_load_dwordx4 a[40:43], v3, s[8:11], s78 offen offset:2048 sc1
  s_waitcnt lgkmcnt(12)
  v_mfma_f32_16x16x32_bf16 v[112:115], v[60:63], v[184:187], v[112:115]
  ds_read_b64_tr_b16 v[32:33], v5 offset:192
  v_mfma_f32_16x16x32_bf16 v[116:119], v[60:63], v[188:191], v[116:119]
  ds_read_b64_tr_b16 v[34:35], v5 offset:3776
  s_waitcnt lgkmcnt(12)
  s_waitcnt vmcnt(18)
  v_mfma_f32_16x16x32_bf16 v[64:67], v[8:11], v[192:195], v[64:67]
  ds_read_b64_tr_b16 v[36:37], v5 offset:7168
  s_waitcnt vmcnt(17)
  v_mfma_f32_16x16x32_bf16 v[68:71], v[8:11], v[196:199], v[68:71]
  ds_read_b64_tr_b16 v[38:39], v5 offset:10752
  buffer_load_dwordx4 a[44:47], v3, s[8:11], s78 offen offset:3072 sc1
  s_add_u32 s77, s77, 4096
  s_cmp_eq_u32 s77, 57344
  s_cselect_b32 s77, 0, s77
  s_waitcnt lgkmcnt(12)
  v_mfma_f32_16x16x32_bf16 v[72:75], v[12:15], v[192:195], v[72:75]
  ds_read_b64_tr_b16 v[40:41], v5 offset:7200
  v_mfma_f32_16x16x32_bf16 v[76:79], v[12:15], v[196:199], v[76:79]
  ds_read_b64_tr_b16 v[42:43], v5 offset:10784
  s_waitcnt lgkmcnt(12)
  v_mfma_f32_16x16x32_bf16 v[80:83], v[16:19], v[192:195], v[80:83]
  ds_read_b64_tr_b16 v[44:45], v5 offset:7232
  v_mfma_f32_16x16x32_bf16 v[84:87], v[16:19], v[196:199], v[84:87]
  ds_read_b64_tr_b16 v[46:47], v5 offset:10816
  s_waitcnt lgkmcnt(12)
  v_mfma_f32_16x16x32_bf16 v[88:91], v[20:23], v[192:195], v[88:91]
  ds_read_b64_tr_b16 v[48:49], v5 offset:7264
  v_mfma_f32_16x16x32_bf16 v[92:95], v[20:23], v[196:199], v[92:95]
  ds_read_b64_tr_b16 v[50:51], v5 offset:10848
  s_add_u32 s78, s76, s77
  buffer_load_dwordx4 a[48:51], v3, s[8:11], s78 offen offset:0 sc1
  s_waitcnt lgkmcnt(12)
  v_mfma_f32_16x16x32_bf16 v[96:99], v[24:27], v[192:195], v[96:99]
  ds_read_b64_tr_b16 v[52:53], v5 offset:7296
  v_mfma_f32_16x16x32_bf16 v[100:103], v[24:27], v[196:199], v[100:103]
  ds_read_b64_tr_b16 v[54:55], v5 offset:10880
  s_waitcnt lgkmcnt(12)
  v_mfma_f32_16x16x32_bf16 v[104:107], v[28:31], v[192:195], v[104:107]
  ds_read_b64_tr_b16 v[56:57], v5 offset:7328
  v_mfma_f32_16x16x32_bf16 v[108:111], v[28:31], v[196:199], v[108:111]
  ds_read_b64_tr_b16 v[58:59], v5 offset:10912
  buffer_load_dwordx4 a[52:55], v3, s[8:11], s78 offen offset:1024 sc1
  s_waitcnt lgkmcnt(12)
  v_mfma_f32_16x16x32_bf16 v[112:115], v[32:35], v[192:195], v[112:115]
  ds_read_b64_tr_b16 v[60:61], v5 offset:7360
  v_mfma_f32_16x16x32_bf16 v[116:119], v[32:35], v[196:199], v[116:119]
  ds_read_b64_tr_b16 v[62:63], v5 offset:10944
  s_waitcnt lgkmcnt(12)
  s_waitcnt vmcnt(19)
  v_mfma_f32_16x16x32_bf16 v[64:67], v[36:39], v[200:203], v[64:67]
  ds_read_b64_tr_b16 v[8:9], v5 offset:14336
  s_waitcnt vmcnt(18)
  v_mfma_f32_16x16x32_bf16 v[68:71], v[36:39], v[204:207], v[68:71]
  ds_read_b64_tr_b16 v[10:11], v5 offset:17920
  buffer_load_dwordx4 a[56:59], v3, s[8:11], s78 offen offset:2048 sc1
  s_waitcnt lgkmcnt(12)
  v_mfma_f32_16x16x32_bf16 v[72:75], v[40:43], v[200:203], v[72:75]
  ds_read_b64_tr_b16 v[12:13], v5 offset:14368
  v_mfma_f32_16x16x32_bf16 v[76:79], v[40:43], v[204:207], v[76:79]
  ds_read_b64_tr_b16 v[14:15], v5 offset:17952
  s_waitcnt lgkmcnt(12)
  v_mfma_f32_16x16x32_bf16 v[80:83], v[44:47], v[200:203], v[80:83]
  ds_read_b64_tr_b16 v[16:17], v5 offset:14400
  v_mfma_f32_16x16x32_bf16 v[84:87], v[44:47], v[204:207], v[84:87]
  ds_read_b64_tr_b16 v[18:19], v5 offset:17984
  buffer_load_dwordx4 a[60:63], v3, s[8:11], s78 offen offset:3072 sc1
  s_add_u32 s77, s77, 4096
  s_cmp_eq_u32 s77, 57344
  s_cselect_b32 s77, 0, s77
  s_waitcnt lgkmcnt(12)
  v_mfma_f32_16x16x32_bf16 v[88:91], v[48:51], v[200:203], v[88:91]
  ds_read_b64_tr_b16 v[20:21], v5 offset:14432
  v_mfma_f32_16x16x32_bf16 v[92:95], v[48:51], v[204:207], v[92:95]
  ds_read_b64_tr_b16 v[22:23], v5 offset:18016
  s_waitcnt lgkmcnt(12)
  v_mfma_f32_16x16x32_bf16 v[96:99], v[52:55], v[200:203], v[96:99]
  ds_read_b64_tr_b16 v[24:25], v5 offset:14464
  v_mfma_f32_16x16x32_bf16 v[100:103], v[52:55], v[204:207], v[100:103]
  ds_read_b64_tr_b16 v[26:27], v5 offset:18048
  s_add_u32 s78, s76, s77
  buffer_load_dwordx4 a[64:67], v3, s[8:11], s78 offen offset:0 sc1
  s_waitcnt lgkmcnt(12)
  v_mfma_f32_16x16x32_bf16 v[104:107], v[56:59], v[200:203], v[104:107]
  ds_read_b64_tr_b16 v[28:29], v5 offset:14496
  v_mfma_f32_16x16x32_bf16 v[108:111], v[56:59], v[204:207], v[108:111]
  ds_read_b64_tr_b16 v[30:31], v5 offset:18080
  s_waitcnt lgkmcnt(12)
  v_mfma_f32_16x16x32_bf16 v[112:115], v[60:63], v[200:203], v[112:115]
  ds_read_b64_tr_b16 v[32:33], v5 offset:14528
  v_mfma_f32_16x16x32_bf16 v[116:119], v[60:63], v[204:207], v[116:119]
  ds_read_b64_tr_b16 v[34:35], v5 offset:18112
  s_waitcnt lgkmcnt(12)
  s_waitcnt vmcnt(20)
  v_mfma_f32_16x16x32_bf16 v[64:67], v[8:11], v[208:211], v[64:67]
  ds_read_b64_tr_b16 v[36:37], v5 offset:21504
  s_waitcnt vmcnt(19)
  v_mfma_f32_16x16x32_bf16 v[68:71], v[8:11], v[212:215], v[68:71]
  ds_read_b64_tr_b16 v[38:39], v5 offset:25088
  buffer_load_dwordx4 a[68:71], v3, s[8:11], s78 offen offset:1024 sc1
  s_waitcnt lgkmcnt(12)
  v_mfma_f32_16x16x32_bf16 v[72:75], v[12:15], v[208:211], v[72:75]
  ds_read_b64_tr_b16 v[40:41], v5 offset:21536
  v_mfma_f32_16x16x32_bf16 v[76:79], v[12:15], v[212:215], v[76:79]
  ds_read_b64_tr_b16 v[42:43], v5 offset:25120
  s_waitcnt lgkmcnt(12)
  v_mfma_f32_16x16x32_bf16 v[80:83], v[16:19], v[208:211], v[80:83]
  ds_read_b64_tr_b16 v[44:45], v5 offset:21568
  v_mfma_f32_16x16x32_bf16 v[84:87], v[16:19], v[212:215], v[84:87]
  ds_read_b64_tr_b16 v[46:47], v5 offset:25152
  buffer_load_dwordx4 a[72:75], v3, s[8:11], s78 offen offset:2048 sc1
  s_waitcnt lgkmcnt(12)
  v_mfma_f32_16x16x32_bf16 v[88:91], v[20:23], v[208:211], v[88:91]
  ds_read_b64_tr_b16 v[48:49], v5 offset:21600
  v_mfma_f32_16x16x32_bf16 v[92:95], v[20:23], v[212:215], v[92:95]
  ds_read_b64_tr_b16 v[50:51], v5 offset:25184
  s_waitcnt lgkmcnt(12)
  v_mfma_f32_16x16x32_bf16 v[96:99], v[24:27], v[208:211], v[96:99]
  ds_read_b64_tr_b16 v[52:53], v5 offset:21632
  v_mfma_f32_16x16x32_bf16 v[100:103], v[24:27], v[212:215], v[100:103]
  ds_read_b64_tr_b16 v[54:55], v5 offset:25216
  buffer_load_dwordx4 a[76:79], v3, s[8:11], s78 offen offset:3072 sc1
  s_add_u32 s77, s77, 4096
  s_cmp_eq_u32 s77, 57344
  s_cselect_b32 s77, 0, s77
  s_waitcnt lgkmcnt(12)
  v_mfma_f32_16x16x32_bf16 v[104:107], v[28:31], v[208:211], v[104:107]
  ds_read_b64_tr_b16 v[56:57], v5 offset:21664
  v_mfma_f32_16x16x32_bf16 v[108:111], v[28:31], v[212:215], v[108:111]
  ds_read_b64_tr_b16 v[58:59], v5 offset:25248
  s_waitcnt lgkmcnt(12)
  v_mfma_f32_16x16x32_bf16 v[112:115], v[32:35], v[208:211], v[112:115]
  ds_read_b64_tr_b16 v[60:61], v5 offset:21696
  v_mfma_f32_16x16x32_bf16 v[116:119], v[32:35], v[212:215], v[116:119]
  ds_read_b64_tr_b16 v[62:63], v5 offset:25280
  s_add_u32 s78, s76, s77
  buffer_load_dwordx4 a[80:83], v3, s[8:11], s78 offen offset:0 sc1
  s_waitcnt lgkmcnt(12)
  s_waitcnt vmcnt(22)
  v_mfma_f32_16x16x32_bf16 v[64:67], v[36:39], v[216:219], v[64:67]
  ds_read_b64_tr_b16 v[8:9], v5 offset:28672
  s_waitcnt vmcnt(21)
  v_mfma_f32_16x16x32_bf16 v[68:71], v[36:39], v[220:223], v[68:71]
  ds_read_b64_tr_b16 v[10:11], v5 offset:32256
  s_waitcnt lgkmcnt(12)
  v_mfma_f32_16x16x32_bf16 v[72:75], v[40:43], v[216:219], v[72:75]
  ds_read_b64_tr_b16 v[12:13], v5 offset:28704
  v_mfma_f32_16x16x32_bf16 v[76:79], v[40:43], v[220:223], v[76:79]
  ds_read_b64_tr_b16 v[14:15], v5 offset:32288
  buffer_load_dwordx4 a[84:87], v3, s[8:11], s78 offen offset:1024 sc1
  s_waitcnt lgkmcnt(12)
  v_mfma_f32_16x16x32_bf16 v[80:83], v[44:47], v[216:219], v[80:83]
  ds_read_b64_tr_b16 v[16:17], v5 offset:28736
  v_mfma_f32_16x16x32_bf16 v[84:87], v[44:47], v[220:223], v[84:87]
  ds_read_b64_tr_b16 v[18:19], v5 offset:32320
  s_waitcnt lgkmcnt(12)
  v_mfma_f32_16x16x32_bf16 v[88:91], v[48:51], v[216:219], v[88:91]
  ds_read_b64_tr_b16 v[20:21], v5 offset:28768
  v_mfma_f32_16x16x32_bf16 v[92:95], v[48:51], v[220:223], v[92:95]
  ds_read_b64_tr_b16 v[22:23], v5 offset:32352
  s_waitcnt lgkmcnt(12)
  v_mfma_f32_16x16x32_bf16 v[96:99], v[52:55], v[216:219], v[96:99]
  ds_read_b64_tr_b16 v[24:25], v5 offset:28800
  v_mfma_f32_16x16x32_bf16 v[100:103], v[52:55], v[220:223], v[100:103]
  ds_read_b64_tr_b16 v[26:27], v5 offset:32384
  buffer_load_dwordx4 a[88:91], v3, s[8:11], s78 offen offset:2048 sc1
  s_waitcnt lgkmcnt(12)
  v_mfma_f32_16x16x32_bf16 v[104:107], v[56:59], v[216:219], v[104:107]
  ds_read_b64_tr_b16 v[28:29], v5 offset:28832
  v_mfma_f32_16x16x32_bf16 v[108:111], v[56:59], v[220:223], v[108:111]
  ds_read_b64_tr_b16 v[30:31], v5 offset:32416
  s_waitcnt lgkmcnt(12)
  v_mfma_f32_16x16x32_bf16 v[112:115], v[60:63], v[216:219], v[112:115]
  ds_read_b64_tr_b16 v[32:33], v5 offset:28864
  v_mfma_f32_16x16x32_bf16 v[116:119], v[60:63], v[220:223], v[116:119]
  ds_read_b64_tr_b16 v[34:35], v5 offset:32448
  buffer_load_dwordx4 a[92:95], v3, s[8:11], s78 offen offset:3072 sc1
  s_add_u32 s77, s77, 4096
  s_cmp_eq_u32 s77, 57344
  s_cselect_b32 s77, 0, s77
  s_waitcnt lgkmcnt(12)
  s_waitcnt vmcnt(23)
  v_mfma_f32_16x16x32_bf16 v[64:67], v[8:11], v[224:227], v[64:67]
  ds_read_b64_tr_b16 v[36:37], v5 offset:35840
  s_waitcnt vmcnt(22)
  v_mfma_f32_16x16x32_bf16 v[68:71], v[8:11], v[228:231], v[68:71]
  ds_read_b64_tr_b16 v[38:39], v5 offset:39424
  s_waitcnt lgkmcnt(12)
  v_mfma_f32_16x16x32_bf16 v[72:75], v[12:15], v[224:227], v[72:75]
  ds_read_b64_tr_b16 v[40:41], v5 offset:35872
  v_mfma_f32_16x16x32_bf16 v[76:79], v[12:15], v[228:231], v[76:79]
  ds_read_b64_tr_b16 v[42:43], v5 offset:39456
  s_add_u32 s78, s76, s77
  buffer_load_dwordx4 a[96:99], v3, s[8:11], s78 offen offset:0 sc1
  s_waitcnt lgkmcnt(12)
  v_mfma_f32_16x16x32_bf16 v[80:83], v[16:19], v[224:227], v[80:83]
  ds_read_b64_tr_b16 v[44:45], v5 offset:35904
  v_mfma_f32_16x16x32_bf16 v[84:87], v[16:19], v[228:231], v[84:87]
  ds_read_b64_tr_b16 v[46:47], v5 offset:39488
  s_waitcnt lgkmcnt(12)
  v_mfma_f32_16x16x32_bf16 v[88:91], v[20:23], v[224:227], v[88:91]
  ds_read_b64_tr_b16 v[48:49], v5 offset:35936
  v_mfma_f32_16x16x32_bf16 v[92:95], v[20:23], v[228:231], v[92:95]
  ds_read_b64_tr_b16 v[50:51], v5 offset:39520
  buffer_load_dwordx4 a[100:103], v3, s[8:11], s78 offen offset:1024 sc1
  s_waitcnt lgkmcnt(12)
  v_mfma_f32_16x16x32_bf16 v[96:99], v[24:27], v[224:227], v[96:99]
  ds_read_b64_tr_b16 v[52:53], v5 offset:35968
  v_mfma_f32_16x16x32_bf16 v[100:103], v[24:27], v[228:231], v[100:103]
  ds_read_b64_tr_b16 v[54:55], v5 offset:39552
  s_waitcnt lgkmcnt(12)
  v_mfma_f32_16x16x32_bf16 v[104:107], v[28:31], v[224:227], v[104:107]
  ds_read_b64_tr_b16 v[56:57], v5 offset:36000
  v_mfma_f32_16x16x32_bf16 v[108:111], v[28:31], v[228:231], v[108:111]
  ds_read_b64_tr_b16 v[58:59], v5 offset:39584
  buffer_load_dwordx4 a[104:107], v3, s[8:11], s78 offen offset:2048 sc1
  s_waitcnt lgkmcnt(12)
  v_mfma_f32_16x16x32_bf16 v[112:115], v[32:35], v[224:227], v[112:115]
  ds_read_b64_tr_b16 v[60:61], v5 offset:36032
  v_mfma_f32_16x16x32_bf16 v[116:119], v[32:35], v[228:231], v[116:119]
  ds_read_b64_tr_b16 v[62:63], v5 offset:39616
  s_waitcnt lgkmcnt(12)
  s_waitcnt vmcnt(24)
  v_mfma_f32_16x16x32_bf16 v[64:67], v[36:39], v[232:235], v[64:67]
  ds_read_b64_tr_b16 v[8:9], v5 offset:43008
  s_waitcnt vmcnt(23)
  v_mfma_f32_16x16x32_bf16 v[68:71], v[36:39], v[236:239], v[68:71]
  ds_read_b64_tr_b16 v[10:11], v5 offset:46592
  s_waitcnt lgkmcnt(12)
  v_mfma_f32_16x16x32_bf16 v[72:75], v[40:43], v[232:235], v[72:75]
  ds_read_b64_tr_b16 v[12:13], v5 offset:43040
  v_mfma_f32_16x16x32_bf16 v[76:79], v[40:43], v[236:239], v[76:79]
  ds_read_b64_tr_b16 v[14:15], v5 offset:46624
  buffer_load_dwordx4 a[108:111], v3, s[8:11], s78 offen offset:3072 sc1
  s_add_u32 s77, s77, 4096
  s_cmp_eq_u32 s77, 57344
  s_cselect_b32 s77, 0, s77
  s_waitcnt lgkmcnt(12)
  v_mfma_f32_16x16x32_bf16 v[80:83], v[44:47], v[232:235], v[80:83]
  ds_read_b64_tr_b16 v[16:17], v5 offset:43072
  v_mfma_f32_16x16x32_bf16 v[84:87], v[44:47], v[236:239], v[84:87]
  ds_read_b64_tr_b16 v[18:19], v5 offset:46656
  s_waitcnt lgkmcnt(12)
  v_mfma_f32_16x16x32_bf16 v[88:91], v[48:51], v[232:235], v[88:91]
  ds_read_b64_tr_b16 v[20:21], v5 offset:43104
  v_mfma_f32_16x16x32_bf16 v[92:95], v[48:51], v[236:239], v[92:95]
  ds_read_b64_tr_b16 v[22:23], v5 offset:46688
  s_add_u32 s78, s76, s77
  buffer_load_dwordx4 a[112:115], v3, s[8:11], s78 offen offset:0 sc1
  s_waitcnt lgkmcnt(12)
  v_mfma_f32_16x16x32_bf16 v[96:99], v[52:55], v[232:235], v[96:99]
  ds_read_b64_tr_b16 v[24:25], v5 offset:43136
  v_mfma_f32_16x16x32_bf16 v[100:103], v[52:55], v[236:239], v[100:103]
  ds_read_b64_tr_b16 v[26:27], v5 offset:46720
  s_waitcnt lgkmcnt(12)
  v_mfma_f32_16x16x32_bf16 v[104:107], v[56:59], v[232:235], v[104:107]
  ds_read_b64_tr_b16 v[28:29], v5 offset:43168
  v_mfma_f32_16x16x32_bf16 v[108:111], v[56:59], v[236:239], v[108:111]
  ds_read_b64_tr_b16 v[30:31], v5 offset:46752
  buffer_load_dwordx4 a[116:119], v3, s[8:11], s78 offen offset:1024 sc1
  s_waitcnt lgkmcnt(12)
  v_mfma_f32_16x16x32_bf16 v[112:115], v[60:63], v[232:235], v[112:115]
  ds_read_b64_tr_b16 v[32:33], v5 offset:43200
  v_mfma_f32_16x16x32_bf16 v[116:119], v[60:63], v[236:239], v[116:119]
  ds_read_b64_tr_b16 v[34:35], v5 offset:46784
  s_waitcnt lgkmcnt(12)
  s_waitcnt vmcnt(25)
  v_mfma_f32_16x16x32_bf16 v[64:67], v[8:11], v[240:243], v[64:67]
  ds_read_b64_tr_b16 v[36:37], v5 offset:50176
  s_waitcnt vmcnt(24)
  v_mfma_f32_16x16x32_bf16 v[68:71], v[8:11], v[244:247], v[68:71]
  ds_read_b64_tr_b16 v[38:39], v5 offset:53760
  buffer_load_dwordx4 a[120:123], v3, s[8:11], s78 offen offset:2048 sc1
  s_waitcnt lgkmcnt(12)
  v_mfma_f32_16x16x32_bf16 v[72:75], v[12:15], v[240:243], v[72:75]
  ds_read_b64_tr_b16 v[40:41], v5 offset:50208
  v_mfma_f32_16x16x32_bf16 v[76:79], v[12:15], v[244:247], v[76:79]
  ds_read_b64_tr_b16 v[42:43], v5 offset:53792
  s_waitcnt lgkmcnt(12)
  v_mfma_f32_16x16x32_bf16 v[80:83], v[16:19], v[240:243], v[80:83]
  ds_read_b64_tr_b16 v[44:45], v5 offset:50240
  v_mfma_f32_16x16x32_bf16 v[84:87], v[16:19], v[244:247], v[84:87]
  ds_read_b64_tr_b16 v[46:47], v5 offset:53824
  buffer_load_dwordx4 a[124:127], v3, s[8:11], s78 offen offset:3072 sc1
  s_add_u32 s77, s77, 4096
  s_cmp_eq_u32 s77, 57344
  s_cselect_b32 s77, 0, s77
  s_waitcnt lgkmcnt(12)
  v_mfma_f32_16x16x32_bf16 v[88:91], v[20:23], v[240:243], v[88:91]
  ds_read_b64_tr_b16 v[48:49], v5 offset:50272
  v_mfma_f32_16x16x32_bf16 v[92:95], v[20:23], v[244:247], v[92:95]
  ds_read_b64_tr_b16 v[50:51], v5 offset:53856
  s_waitcnt lgkmcnt(12)
  v_mfma_f32_16x16x32_bf16 v[96:99], v[24:27], v[240:243], v[96:99]
  ds_read_b64_tr_b16 v[52:53], v5 offset:50304
  v_mfma_f32_16x16x32_bf16 v[100:103], v[24:27], v[244:247], v[100:103]
  ds_read_b64_tr_b16 v[54:55], v5 offset:53888
  s_waitcnt lgkmcnt(12)
  v_mfma_f32_16x16x32_bf16 v[104:107], v[28:31], v[240:243], v[104:107]
  ds_read_b64_tr_b16 v[56:57], v5 offset:50336
  v_mfma_f32_16x16x32_bf16 v[108:111], v[28:31], v[244:247], v[108:111]
  ds_read_b64_tr_b16 v[58:59], v5 offset:53920
  s_waitcnt lgkmcnt(12)
  v_mfma_f32_16x16x32_bf16 v[112:115], v[32:35], v[240:243], v[112:115]
  ds_read_b64_tr_b16 v[60:61], v5 offset:50368
  v_mfma_f32_16x16x32_bf16 v[116:119], v[32:35], v[244:247], v[116:119]
  ds_read_b64_tr_b16 v[62:63], v5 offset:53952
  s_waitcnt lgkmcnt(12)
  s_waitcnt vmcnt(25)
  v_mfma_f32_16x16x32_bf16 v[64:67], v[36:39], v[248:251], v[64:67]
  s_waitcnt vmcnt(24)
  v_mfma_f32_16x16x32_bf16 v[68:71], v[36:39], v[252:255], v[68:71]
  s_waitcnt lgkmcnt(10)
  v_mfma_f32_16x16x32_bf16 v[72:75], v[40:43], v[248:251], v[72:75]
  v_mfma_f32_16x16x32_bf16 v[76:79], v[40:43], v[252:255], v[76:79]
  s_waitcnt lgkmcnt(8)
  v_mfma_f32_16x16x32_bf16 v[80:83], v[44:47], v[248:251], v[80:83]
  v_mfma_f32_16x16x32_bf16 v[84:87], v[44:47], v[252:255], v[84:87]
  s_waitcnt lgkmcnt(6)
  v_mfma_f32_16x16x32_bf16 v[88:91], v[48:51], v[248:251], v[88:91]
  v_mfma_f32_16x16x32_bf16 v[92:95], v[48:51], v[252:255], v[92:95]
  s_waitcnt lgkmcnt(4)
  v_mfma_f32_16x16x32_bf16 v[96:99], v[52:55], v[248:251], v[96:99]
  v_mfma_f32_16x16x32_bf16 v[100:103], v[52:55], v[252:255], v[100:103]
  s_waitcnt lgkmcnt(2)
  v_mfma_f32_16x16x32_bf16 v[104:107], v[56:59], v[248:251], v[104:107]
  v_mfma_f32_16x16x32_bf16 v[108:111], v[56:59], v[252:255], v[108:111]
  s_waitcnt lgkmcnt(0)
  v_mfma_f32_16x16x32_bf16 v[112:115], v[60:63], v[248:251], v[112:115]
  v_mfma_f32_16x16x32_bf16 v[116:119], v[60:63], v[252:255], v[116:119]
  s_mul_i32 s72, s34, 458752
  s_mul_i32 s73, s33, 114688
  s_add_u32 s72, s72, s73
  s_add_u32 s72, s72, 10485760
  s_lshl_b32 s73, s34, 17
  s_cmp_eq_u32 s33, 0
  s_cselect_b32 s72, s73, s72
  s_lshr_b32 s73, s35, 2
  s_and_b32 s74, s35, 3
  s_mul_i32 s73, s73, 14336
  s_add_u32 s72, s72, s73
  s_mul_i32 s73, s74, 3072
  s_add_u32 s73, s73, s72
  s_add_u32 s80, s73, 57344
  s_lshl_b32 s74, s74, 9
  s_add_u32 s74, s74, s72
  s_add_u32 s74, s74, 12288
  v_and_b32 v4, 1, v1
  v_mul_u32_u24 v4, 57344, v4
  v_lshrrev_b32 v5, 1, v1
  v_lshl_add_u32 v4, v5, 8, v4
  v_lshl_add_u32 v4, v2, 4, v4
  v_cvt_pk_bf16_f32 v8, v64, v65
  v_cvt_pk_bf16_f32 v9, v66, v67
  v_cvt_pk_bf16_f32 v10, v72, v73
  v_cvt_pk_bf16_f32 v11, v74, v75
  v_pk_max_i16 v8, v8, 0
  v_pk_max_i16 v9, v9, 0
  v_pk_max_i16 v10, v10, 0
  v_pk_max_i16 v11, v11, 0
  v_cvt_pk_bf16_f32 v12, v80, v81
  v_cvt_pk_bf16_f32 v13, v82, v83
  v_cvt_pk_bf16_f32 v14, v88, v89
  v_cvt_pk_bf16_f32 v15, v90, v91
  v_pk_max_i16 v12, v12, 0
  v_pk_max_i16 v13, v13, 0
  v_pk_max_i16 v14, v14, 0
  v_pk_max_i16 v15, v15, 0
  v_cvt_pk_bf16_f32 v16, v96, v97
  v_cvt_pk_bf16_f32 v17, v98, v99
  v_cvt_pk_bf16_f32 v18, v104, v105
  v_cvt_pk_bf16_f32 v19, v106, v107
  v_pk_max_i16 v16, v16, 0
  v_pk_max_i16 v17, v17, 0
  v_pk_max_i16 v18, v18, 0
  v_pk_max_i16 v19, v19, 0
  v_cvt_pk_bf16_f32 v20, v68, v69
  v_cvt_pk_bf16_f32 v21, v70, v71
  v_cvt_pk_bf16_f32 v22, v76, v77
  v_cvt_pk_bf16_f32 v23, v78, v79
  v_pk_max_i16 v20, v20, 0
  v_pk_max_i16 v21, v21, 0
  v_pk_max_i16 v22, v22, 0
  v_pk_max_i16 v23, v23, 0
  v_cvt_pk_bf16_f32 v24, v84, v85
  v_cvt_pk_bf16_f32 v25, v86, v87
  v_cvt_pk_bf16_f32 v26, v92, v93
  v_cvt_pk_bf16_f32 v27, v94, v95
  v_pk_max_i16 v24, v24, 0
  v_pk_max_i16 v25, v25, 0
  v_pk_max_i16 v26, v26, 0
  v_pk_max_i16 v27, v27, 0
  v_cvt_pk_bf16_f32 v28, v100, v101
  v_cvt_pk_bf16_f32 v29, v102, v103
  v_cvt_pk_bf16_f32 v30, v108, v109
  v_cvt_pk_bf16_f32 v31, v110, v111
  v_pk_max_i16 v28, v28, 0
  v_pk_max_i16 v29, v29, 0
  v_pk_max_i16 v30, v30, 0
  v_pk_max_i16 v31, v31, 0
  v_cvt_pk_bf16_f32 v32, v112, v113
  v_cvt_pk_bf16_f32 v33, v114, v115
  v_cvt_pk_bf16_f32 v34, v116, v117
  v_cvt_pk_bf16_f32 v35, v118, v119
  v_pk_max_i16 v32, v32, 0
  v_pk_max_i16 v33, v33, 0
  v_pk_max_i16 v34, v34, 0
  v_pk_max_i16 v35, v35, 0
  s_nop 0
  v_permlane16_swap_b32 v32, v34
  v_permlane16_swap_b32 v33, v35
  s_cmp_eq_u32 s83, 1
  s_cbranch_scc0 adaLN_cond__spectral_fnet__dense_activation_relu__prompt_kernel_h1_slow
  buffer_store_dwordx4 v[8:11], v3, s[8:11], s73 offen offset:0
  buffer_store_dwordx4 v[12:15], v3, s[8:11], s73 offen offset:1024
  buffer_store_dwordx4 v[16:19], v3, s[8:11], s73 offen offset:2048
  buffer_store_dwordx4 v[20:23], v3, s[8:11], s80 offen offset:0
  buffer_store_dwordx4 v[24:27], v3, s[8:11], s80 offen offset:1024
  buffer_store_dwordx4 v[28:31], v3, s[8:11], s80 offen offset:2048
  buffer_store_dwordx4 v[32:35], v4, s[8:11], s74 offen
  s_branch adaLN_cond__spectral_fnet__dense_activation_relu__prompt_kernel_h1_done
adaLN_cond__spectral_fnet__dense_activation_relu__prompt_kernel_h1_slow:
  buffer_store_dwordx4 v[8:11], v3, s[8:11], s73 offen offset:0 sc1
  buffer_store_dwordx4 v[12:15], v3, s[8:11], s73 offen offset:1024 sc1
  buffer_store_dwordx4 v[16:19], v3, s[8:11], s73 offen offset:2048 sc1
  buffer_store_dwordx4 v[20:23], v3, s[8:11], s80 offen offset:0 sc1
  buffer_store_dwordx4 v[24:27], v3, s[8:11], s80 offen offset:1024 sc1
  buffer_store_dwordx4 v[28:31], v3, s[8:11], s80 offen offset:2048 sc1
  buffer_store_dwordx4 v[32:35], v4, s[8:11], s74 offen sc1
adaLN_cond__spectral_fnet__dense_activation_relu__prompt_kernel_h1_done:
  s_lshl_b32 s60, s34, 11
  s_lshl_b32 s61, s35, 7
  s_add_u32 s60, s60, s61
  s_add_u32 s60, s60, 8585216
  v_mov_b32 v5, s101
  v_mov_b32 v6, 0
  s_waitcnt vmcnt(0)
  s_barrier
  s_cmp_lg_u32 s33, 0
  s_cbranch_scc1 adaLN_cond__spectral_fnet__dense_activation_relu__prompt_kernel_pc_nf
  s_mov_b64 exec, 1
  s_cmp_eq_u32 s83, 1
  s_cbranch_scc0 adaLN_cond__spectral_fnet__dense_activation_relu__prompt_kernel_pc_fs
  buffer_store_dword v5, v6, s[8:11], s60 offen
  s_branch adaLN_cond__spectral_fnet__dense_activation_relu__prompt_kernel_pc_fd
adaLN_cond__spectral_fnet__dense_activation_relu__prompt_kernel_pc_fs:
  buffer_store_dword v5, v6, s[8:11], s60 offen sc1
adaLN_cond__spectral_fnet__dense_activation_relu__prompt_kernel_pc_fd:
  s_mov_b64 exec, -1
adaLN_cond__spectral_fnet__dense_activation_relu__prompt_kernel_pc_nf:
  s_add_u32 s78, s76, s77
  buffer_load_dwordx4 a[128:131], v3, s[8:11], s78 offen offset:0 sc1
  buffer_load_dwordx4 a[132:135], v3, s[8:11], s78 offen offset:1024 sc1
  buffer_load_dwordx4 a[136:139], v3, s[8:11], s78 offen offset:2048 sc1
  buffer_load_dwordx4 a[140:143], v3, s[8:11], s78 offen offset:3072 sc1
  s_add_u32 s77, s77, 4096
  s_cmp_eq_u32 s77, 57344
  s_cselect_b32 s77, 0, s77
  s_add_u32 s78, s76, s77
  buffer_load_dwordx4 a[144:147], v3, s[8:11], s78 offen offset:0 sc1
  buffer_load_dwordx4 a[148:151], v3, s[8:11], s78 offen offset:1024 sc1
  buffer_load_dwordx4 a[152:155], v3, s[8:11], s78 offen offset:2048 sc1
  buffer_load_dwordx4 a[156:159], v3, s[8:11], s78 offen offset:3072 sc1
  s_add_u32 s77, s77, 4096
  s_cmp_eq_u32 s77, 57344
  s_cselect_b32 s77, 0, s77
  s_add_u32 s78, s76, s77
  buffer_load_dwordx4 a[160:163], v3, s[8:11], s78 offen offset:0 sc1
  buffer_load_dwordx4 a[164:167], v3, s[8:11], s78 offen offset:1024 sc1
  buffer_load_dwordx4 a[168:171], v3, s[8:11], s78 offen offset:2048 sc1
  buffer_load_dwordx4 a[172:175], v3, s[8:11], s78 offen offset:3072 sc1
  s_add_u32 s77, s77, 4096
  s_cmp_eq_u32 s77, 57344
  s_cselect_b32 s77, 0, s77
  s_add_u32 s78, s76, s77
  buffer_load_dwordx4 a[176:179], v3, s[8:11], s78 offen offset:0 sc1
  buffer_load_dwordx4 a[180:183], v3, s[8:11], s78 offen offset:1024 sc1
  buffer_load_dwordx4 a[184:187], v3, s[8:11], s78 offen offset:2048 sc1
  buffer_load_dwordx4 a[188:191], v3, s[8:11], s78 offen offset:3072 sc1
  s_add_u32 s77, s77, 4096
  s_cmp_eq_u32 s77, 57344
  s_cselect_b32 s77, 0, s77
  s_add_u32 s78, s76, s77
  buffer_load_dwordx4 a[192:195], v3, s[8:11], s78 offen offset:0 sc1
  buffer_load_dwordx4 a[196:199], v3, s[8:11], s78 offen offset:1024 sc1
  buffer_load_dwordx4 a[200:203], v3, s[8:11], s78 offen offset:2048 sc1
  buffer_load_dwordx4 a[204:207], v3, s[8:11], s78 offen offset:3072 sc1
  s_add_u32 s77, s77, 4096
  s_cmp_eq_u32 s77, 57344
  s_cselect_b32 s77, 0, s77
  s_add_u32 s78, s76, s77
  buffer_load_dwordx4 a[208:211], v3, s[8:11], s78 offen offset:0 sc1
  buffer_load_dwordx4 a[212:215], v3, s[8:11], s78 offen offset:1024 sc1
  buffer_load_dwordx4 a[216:219], v3, s[8:11], s78 offen offset:2048 sc1
  buffer_load_dwordx4 a[220:223], v3, s[8:11], s78 offen offset:3072 sc1
  s_add_u32 s77, s77, 4096
  s_cmp_eq_u32 s77, 57344
  s_cselect_b32 s77, 0, s77
  v_lshrrev_b32 v4, 2, v0
  s_lshl_b32 s72, s33, 4
  v_add_u32 v4, s72, v4
  v_and_b32 v5, 3, v0
  s_lshr_b32 s73, s35, 3
  s_lshl_b32 s73, s73, 6
  v_add_u32 v6, s73, v4
  s_and_b32 s74, s35, 7
  s_lshl_b32 s74, s74, 7
  v_lshlrev_b32 v7, 5, v5
  v_add_u32 v7, s74, v7
  v_lshl_add_u32 v8, v6, 10, v7
  v_lshrrev_b32 v9, 3, v6
  v_lshlrev_b32 v9, 2, v9
  v_and_b32 v10, 3, v6
  v_add_u32 v9, v9, v10
  s_sub_u32 s73, 32, s34
  s_cmp_eq_u32 s34, 0
  s_cselect_b32 s73, 16, s73
  v_and_b32 v10, 4, v6
  v_cmp_eq_u32 vcc, 0, v10
  v_mov_b32 v10, s73
  v_mov_b32 v11, s34
  v_cndmask_b32 v10, v10, v11, vcc
  v_lshl_add_u32 v9, v9, 5, v10
  v_lshl_add_u32 v9, v9, 10, v7
  v_mul_u32_u24 v10, 272, v2
  v_lshl_add_u32 v10, v1, 6, v10
  s_mul_i32 s73, s33, 17408
  s_add_u32 s73, s73, 49152
  v_add_u32 v10, s73, v10
  v_mul_u32_u24 v11, 272, v4
  v_lshl_add_u32 v11, v5, 6, v11
  v_add_u32 v11, 49152, v11
  v_lshlrev_b32 v12, 1, v7
  ds_read_b128 v[16:19], v12 offset:6144
  ds_read_b128 v[20:23], v12 offset:6160
  ds_read_b128 v[24:27], v12 offset:6176
  ds_read_b128 v[28:31], v12 offset:6192
  s_mul_i32 s72, s34, 458752
  s_lshr_b32 s73, s35, 3
  s_mul_i32 s73, s73, 229376
  s_add_u32 s72, s72, s73
  s_mul_i32 s73, s33, 14336
  s_add_u32 s72, s72, s73
  s_add_u32 s72, s72, 10485760
  s_add_u32 s75, s72, 114688
  s_lshl_b32 s74, s34, 17
  s_add_u32 s74, s74, s73
  s_lshr_b32 s77, s35, 3
  s_cmp_eq_u32 s77, 0
  s_cselect_b32 s72, s74, s72
  s_lshl_b32 s73, s79, 10
  s_lshl_b32 s74, s34, 17
  s_add_u32 s74, s74, 4194304
  s_waitcnt lgkmcnt(0)
  s_cmp_lg_u32 s33, 0
  s_cbranch_scc1 adaLN_cond__spectral_fnet__dense_activation_relu__prompt_kernel_qc_pd
  s_lshl_b32 s60, s34, 11
  v_lshlrev_b32 v6, 7, v2
  s_add_u32 s60, s60, 8585216
  s_mov_b32 s61, 65536
adaLN_cond__spectral_fnet__dense_activation_relu__prompt_kernel_qc_pl:
  buffer_load_dword v5, v6, s[8:11], s60 offen sc1
  s_sub_u32 s61, s61, 1
  s_waitcnt vmcnt(0)
  v_cmp_ne_u32 vcc, s101, v5
  s_cmp_eq_u32 s61, 0
  s_cbranch_scc1 adaLN_cond__spectral_fnet__dense_activation_relu__prompt_kernel_qc_pd
  s_cbranch_vccnz adaLN_cond__spectral_fnet__dense_activation_relu__prompt_kernel_qc_pl
adaLN_cond__spectral_fnet__dense_activation_relu__prompt_kernel_qc_pd:
  s_barrier
  s_add_u32 s80, s72, s73
  buffer_load_dwordx4 v[96:99], v3, s[8:11], s80 offen sc1
  s_add_u32 s81, s80, 57344
  buffer_load_dwordx4 v[100:103], v3, s[8:11], s81 offen sc1
  s_add_u32 s80, s75, s73
  buffer_load_dwordx4 v[104:107], v3, s[8:11], s80 offen sc1
  s_add_u32 s81, s80, 57344
  buffer_load_dwordx4 v[108:111], v3, s[8:11], s81 offen sc1
  s_add_u32 s73, s73, 1024
  s_cmp_eq_u32 s73, 14336
  s_cselect_b32 s73, 0, s73
  s_add_u32 s80, s72, s73
  buffer_load_dwordx4 v[112:115], v3, s[8:11], s80 offen sc1
  s_add_u32 s81, s80, 57344
  buffer_load_dwordx4 v[116:119], v3, s[8:11], s81 offen sc1
  s_add_u32 s80, s75, s73
  buffer_load_dwordx4 v[120:123], v3, s[8:11], s80 offen sc1
  s_add_u32 s81, s80, 57344
  buffer_load_dwordx4 v[124:127], v3, s[8:11], s81 offen sc1
  s_add_u32 s73, s73, 1024
  s_cmp_eq_u32 s73, 14336
  s_cselect_b32 s73, 0, s73
  s_add_u32 s80, s72, s73
  buffer_load_dwordx4 v[128:131], v3, s[8:11], s80 offen sc1
  s_add_u32 s81, s80, 57344
  buffer_load_dwordx4 v[132:135], v3, s[8:11], s81 offen sc1
  s_add_u32 s80, s75, s73
  buffer_load_dwordx4 v[136:139], v3, s[8:11], s80 offen sc1
  s_add_u32 s81, s80, 57344
  buffer_load_dwordx4 v[140:143], v3, s[8:11], s81 offen sc1
  s_add_u32 s73, s73, 1024
  s_cmp_eq_u32 s73, 14336
  s_cselect_b32 s73, 0, s73
  s_waitcnt vmcnt(11)
  v_mfma_f32_16x16x32_bf16 v[32:35], a[0:3], v[96:99], 0
  v_mfma_f32_16x16x32_bf16 v[36:39], a[4:7], v[96:99], 0
  v_mfma_f32_16x16x32_bf16 v[40:43], a[8:11], v[96:99], 0
  v_mfma_f32_16x16x32_bf16 v[44:47], a[12:15], v[96:99], 0
  s_add_u32 s80, s72, s73
  buffer_load_dwordx4 v[144:147], v3, s[8:11], s80 offen sc1
  s_waitcnt vmcnt(11)
  v_mfma_f32_16x16x32_bf16 v[48:51], a[0:3], v[100:103], 0
  v_mfma_f32_16x16x32_bf16 v[52:55], a[4:7], v[100:103], 0
  v_mfma_f32_16x16x32_bf16 v[56:59], a[8:11], v[100:103], 0
  v_mfma_f32_16x16x32_bf16 v[60:63], a[12:15], v[100:103], 0
  s_add_u32 s81, s80, 57344
  buffer_load_dwordx4 v[148:151], v3, s[8:11], s81 offen sc1
  s_waitcnt vmcnt(11)
  v_mfma_f32_16x16x32_bf16 v[64:67], a[0:3], v[104:107], 0
  v_mfma_f32_16x16x32_bf16 v[68:71], a[4:7], v[104:107], 0
  v_mfma_f32_16x16x32_bf16 v[72:75], a[8:11], v[104:107], 0
  v_mfma_f32_16x16x32_bf16 v[76:79], a[12:15], v[104:107], 0
  s_add_u32 s80, s75, s73
  buffer_load_dwordx4 v[152:155], v3, s[8:11], s80 offen sc1
  s_waitcnt vmcnt(11)
  v_mfma_f32_16x16x32_bf16 v[80:83], a[0:3], v[108:111], 0
  v_mfma_f32_16x16x32_bf16 v[84:87], a[4:7], v[108:111], 0
  v_mfma_f32_16x16x32_bf16 v[88:91], a[8:11], v[108:111], 0
  v_mfma_f32_16x16x32_bf16 v[92:95], a[12:15], v[108:111], 0
  s_add_u32 s81, s80, 57344
  buffer_load_dwordx4 v[156:159], v3, s[8:11], s81 offen sc1
  s_add_u32 s73, s73, 1024
  s_cmp_eq_u32 s73, 14336
  s_cselect_b32 s73, 0, s73
  s_waitcnt vmcnt(11)
  v_mfma_f32_16x16x32_bf16 v[32:35], a[16:19], v[112:115], v[32:35]
  v_mfma_f32_16x16x32_bf16 v[36:39], a[20:23], v[112:115], v[36:39]
  v_mfma_f32_16x16x32_bf16 v[40:43], a[24:27], v[112:115], v[40:43]
  v_mfma_f32_16x16x32_bf16 v[44:47], a[28:31], v[112:115], v[44:47]
  s_add_u32 s80, s72, s73
  buffer_load_dwordx4 v[96:99], v3, s[8:11], s80 offen sc1
  s_waitcnt vmcnt(11)
  v_mfma_f32_16x16x32_bf16 v[48:51], a[16:19], v[116:119], v[48:51]
  v_mfma_f32_16x16x32_bf16 v[52:55], a[20:23], v[116:119], v[52:55]
  v_mfma_f32_16x16x32_bf16 v[56:59], a[24:27], v[116:119], v[56:59]
  v_mfma_f32_16x16x32_bf16 v[60:63], a[28:31], v[116:119], v[60:63]
  s_add_u32 s81, s80, 57344
  buffer_load_dwordx4 v[100:103], v3, s[8:11], s81 offen sc1
  s_waitcnt vmcnt(11)
  v_mfma_f32_16x16x32_bf16 v[64:67], a[16:19], v[120:123], v[64:67]
  v_mfma_f32_16x16x32_bf16 v[68:71], a[20:23], v[120:123], v[68:71]
  v_mfma_f32_16x16x32_bf16 v[72:75], a[24:27], v[120:123], v[72:75]
  v_mfma_f32_16x16x32_bf16 v[76:79], a[28:31], v[120:123], v[76:79]
  s_add_u32 s80, s75, s73
  buffer_load_dwordx4 v[104:107], v3, s[8:11], s80 offen sc1
  s_waitcnt vmcnt(11)
  v_mfma_f32_16x16x32_bf16 v[80:83], a[16:19], v[124:127], v[80:83]
  v_mfma_f32_16x16x32_bf16 v[84:87], a[20:23], v[124:127], v[84:87]
  v_mfma_f32_16x16x32_bf16 v[88:91], a[24:27], v[124:127], v[88:91]
  v_mfma_f32_16x16x32_bf16 v[92:95], a[28:31], v[124:127], v[92:95]
  s_add_u32 s81, s80, 57344
  buffer_load_dwordx4 v[108:111], v3, s[8:11], s81 offen sc1
  s_add_u32 s73, s73, 1024
  s_cmp_eq_u32 s73, 14336
  s_cselect_b32 s73, 0, s73
  s_waitcnt vmcnt(11)
  v_mfma_f32_16x16x32_bf16 v[32:35], a[32:35], v[128:131], v[32:35]
  v_mfma_f32_16x16x32_bf16 v[36:39], a[36:39], v[128:131], v[36:39]
  v_mfma_f32_16x16x32_bf16 v[40:43], a[40:43], v[128:131], v[40:43]
  v_mfma_f32_16x16x32_bf16 v[44:47], a[44:47], v[128:131], v[44:47]
  s_add_u32 s80, s72, s73
  buffer_load_dwordx4 v[112:115], v3, s[8:11], s80 offen sc1
  s_waitcnt vmcnt(11)
  v_mfma_f32_16x16x32_bf16 v[48:51], a[32:35], v[132:135], v[48:51]
  v_mfma_f32_16x16x32_bf16 v[52:55], a[36:39], v[132:135], v[52:55]
  v_mfma_f32_16x16x32_bf16 v[56:59], a[40:43], v[132:135], v[56:59]
  v_mfma_f32_16x16x32_bf16 v[60:63], a[44:47], v[132:135], v[60:63]
  s_add_u32 s81, s80, 57344
  buffer_load_dwordx4 v[116:119], v3, s[8:11], s81 offen sc1
  s_waitcnt vmcnt(11)
  v_mfma_f32_16x16x32_bf16 v[64:67], a[32:35], v[136:139], v[64:67]
  v_mfma_f32_16x16x32_bf16 v[68:71], a[36:39], v[136:139], v[68:71]
  v_mfma_f32_16x16x32_bf16 v[72:75], a[40:43], v[136:139], v[72:75]
  v_mfma_f32_16x16x32_bf16 v[76:79], a[44:47], v[136:139], v[76:79]
  s_add_u32 s80, s75, s73
  buffer_load_dwordx4 v[120:123], v3, s[8:11], s80 offen sc1
  s_waitcnt vmcnt(11)
  v_mfma_f32_16x16x32_bf16 v[80:83], a[32:35], v[140:143], v[80:83]
  v_mfma_f32_16x16x32_bf16 v[84:87], a[36:39], v[140:143], v[84:87]
  v_mfma_f32_16x16x32_bf16 v[88:91], a[40:43], v[140:143], v[88:91]
  v_mfma_f32_16x16x32_bf16 v[92:95], a[44:47], v[140:143], v[92:95]
  s_add_u32 s81, s80, 57344
  buffer_load_dwordx4 v[124:127], v3, s[8:11], s81 offen sc1
  s_add_u32 s73, s73, 1024
  s_cmp_eq_u32 s73, 14336
  s_cselect_b32 s73, 0, s73
  s_waitcnt vmcnt(11)
  v_mfma_f32_16x16x32_bf16 v[32:35], a[48:51], v[144:147], v[32:35]
  v_mfma_f32_16x16x32_bf16 v[36:39], a[52:55], v[144:147], v[36:39]
  v_mfma_f32_16x16x32_bf16 v[40:43], a[56:59], v[144:147], v[40:43]
  v_mfma_f32_16x16x32_bf16 v[44:47], a[60:63], v[144:147], v[44:47]
  s_add_u32 s80, s72, s73
  buffer_load_dwordx4 v[128:131], v3, s[8:11], s80 offen sc1
  s_waitcnt vmcnt(11)
  v_mfma_f32_16x16x32_bf16 v[48:51], a[48:51], v[148:151], v[48:51]
  v_mfma_f32_16x16x32_bf16 v[52:55], a[52:55], v[148:151], v[52:55]
  v_mfma_f32_16x16x32_bf16 v[56:59], a[56:59], v[148:151], v[56:59]
  v_mfma_f32_16x16x32_bf16 v[60:63], a[60:63], v[148:151], v[60:63]
  s_add_u32 s81, s80, 57344
  buffer_load_dwordx4 v[132:135], v3, s[8:11], s81 offen sc1
  s_waitcnt vmcnt(11)
  v_mfma_f32_16x16x32_bf16 v[64:67], a[48:51], v[152:155], v[64:67]
  v_mfma_f32_16x16x32_bf16 v[68:71], a[52:55], v[152:155], v[68:71]
  v_mfma_f32_16x16x32_bf16 v[72:75], a[56:59], v[152:155], v[72:75]
  v_mfma_f32_16x16x32_bf16 v[76:79], a[60:63], v[152:155], v[76:79]
  s_add_u32 s80, s75, s73
  buffer_load_dwordx4 v[136:139], v3, s[8:11], s80 offen sc1
  s_waitcnt vmcnt(11)
  v_mfma_f32_16x16x32_bf16 v[80:83], a[48:51], v[156:159], v[80:83]
  v_mfma_f32_16x16x32_bf16 v[84:87], a[52:55], v[156:159], v[84:87]
  v_mfma_f32_16x16x32_bf16 v[88:91], a[56:59], v[156:159], v[88:91]
  v_mfma_f32_16x16x32_bf16 v[92:95], a[60:63], v[156:159], v[92:95]
  s_add_u32 s81, s80, 57344
  buffer_load_dwordx4 v[140:143], v3, s[8:11], s81 offen sc1
  s_add_u32 s73, s73, 1024
  s_cmp_eq_u32 s73, 14336
  s_cselect_b32 s73, 0, s73
  s_waitcnt vmcnt(11)
  v_mfma_f32_16x16x32_bf16 v[32:35], a[64:67], v[96:99], v[32:35]
  v_mfma_f32_16x16x32_bf16 v[36:39], a[68:71], v[96:99], v[36:39]
  v_mfma_f32_16x16x32_bf16 v[40:43], a[72:75], v[96:99], v[40:43]
  v_mfma_f32_16x16x32_bf16 v[44:47], a[76:79], v[96:99], v[44:47]
  s_add_u32 s80, s72, s73
  buffer_load_dwordx4 v[144:147], v3, s[8:11], s80 offen sc1
  s_waitcnt vmcnt(11)
  v_mfma_f32_16x16x32_bf16 v[48:51], a[64:67], v[100:103], v[48:51]
  v_mfma_f32_16x16x32_bf16 v[52:55], a[68:71], v[100:103], v[52:55]
  v_mfma_f32_16x16x32_bf16 v[56:59], a[72:75], v[100:103], v[56:59]
  v_mfma_f32_16x16x32_bf16 v[60:63], a[76:79], v[100:103], v[60:63]
  s_add_u32 s81, s80, 57344
  buffer_load_dwordx4 v[148:151], v3, s[8:11], s81 offen sc1
  s_waitcnt vmcnt(11)
  v_mfma_f32_16x16x32_bf16 v[64:67], a[64:67], v[104:107], v[64:67]
  v_mfma_f32_16x16x32_bf16 v[68:71], a[68:71], v[104:107], v[68:71]
  v_mfma_f32_16x16x32_bf16 v[72:75], a[72:75], v[104:107], v[72:75]
  v_mfma_f32_16x16x32_bf16 v[76:79], a[76:79], v[104:107], v[76:79]
  s_add_u32 s80, s75, s73
  buffer_load_dwordx4 v[152:155], v3, s[8:11], s80 offen sc1
  s_waitcnt vmcnt(11)
  v_mfma_f32_16x16x32_bf16 v[80:83], a[64:67], v[108:111], v[80:83]
  v_mfma_f32_16x16x32_bf16 v[84:87], a[68:71], v[108:111], v[84:87]
  v_mfma_f32_16x16x32_bf16 v[88:91], a[72:75], v[108:111], v[88:91]
  v_mfma_f32_16x16x32_bf16 v[92:95], a[76:79], v[108:111], v[92:95]
  s_add_u32 s81, s80, 57344
  buffer_load_dwordx4 v[156:159], v3, s[8:11], s81 offen sc1
  s_add_u32 s73, s73, 1024
  s_cmp_eq_u32 s73, 14336
  s_cselect_b32 s73, 0, s73
  s_waitcnt vmcnt(11)
  v_mfma_f32_16x16x32_bf16 v[32:35], a[80:83], v[112:115], v[32:35]
  v_mfma_f32_16x16x32_bf16 v[36:39], a[84:87], v[112:115], v[36:39]
  v_mfma_f32_16x16x32_bf16 v[40:43], a[88:91], v[112:115], v[40:43]
  v_mfma_f32_16x16x32_bf16 v[44:47], a[92:95], v[112:115], v[44:47]
  s_add_u32 s80, s72, s73
  buffer_load_dwordx4 v[96:99], v3, s[8:11], s80 offen sc1
  s_waitcnt vmcnt(11)
  v_mfma_f32_16x16x32_bf16 v[48:51], a[80:83], v[116:119], v[48:51]
  v_mfma_f32_16x16x32_bf16 v[52:55], a[84:87], v[116:119], v[52:55]
  v_mfma_f32_16x16x32_bf16 v[56:59], a[88:91], v[116:119], v[56:59]
  v_mfma_f32_16x16x32_bf16 v[60:63], a[92:95], v[116:119], v[60:63]
  s_add_u32 s81, s80, 57344
  buffer_load_dwordx4 v[100:103], v3, s[8:11], s81 offen sc1
  s_waitcnt vmcnt(11)
  v_mfma_f32_16x16x32_bf16 v[64:67], a[80:83], v[120:123], v[64:67]
  v_mfma_f32_16x16x32_bf16 v[68:71], a[84:87], v[120:123], v[68:71]
  v_mfma_f32_16x16x32_bf16 v[72:75], a[88:91], v[120:123], v[72:75]
  v_mfma_f32_16x16x32_bf16 v[76:79], a[92:95], v[120:123], v[76:79]
  s_add_u32 s80, s75, s73
  buffer_load_dwordx4 v[104:107], v3, s[8:11], s80 offen sc1
  s_waitcnt vmcnt(11)
  v_mfma_f32_16x16x32_bf16 v[80:83], a[80:83], v[124:127], v[80:83]
  v_mfma_f32_16x16x32_bf16 v[84:87], a[84:87], v[124:127], v[84:87]
  v_mfma_f32_16x16x32_bf16 v[88:91], a[88:91], v[124:127], v[88:91]
  v_mfma_f32_16x16x32_bf16 v[92:95], a[92:95], v[124:127], v[92:95]
  s_add_u32 s81, s80, 57344
  buffer_load_dwordx4 v[108:111], v3, s[8:11], s81 offen sc1
  s_add_u32 s73, s73, 1024
  s_cmp_eq_u32 s73, 14336
  s_cselect_b32 s73, 0, s73
  s_waitcnt vmcnt(11)
  v_mfma_f32_16x16x32_bf16 v[32:35], a[96:99], v[128:131], v[32:35]
  v_mfma_f32_16x16x32_bf16 v[36:39], a[100:103], v[128:131], v[36:39]
  v_mfma_f32_16x16x32_bf16 v[40:43], a[104:107], v[128:131], v[40:43]
  v_mfma_f32_16x16x32_bf16 v[44:47], a[108:111], v[128:131], v[44:47]
  s_add_u32 s80, s72, s73
  buffer_load_dwordx4 v[112:115], v3, s[8:11], s80 offen sc1
  s_waitcnt vmcnt(11)
  v_mfma_f32_16x16x32_bf16 v[48:51], a[96:99], v[132:135], v[48:51]
  v_mfma_f32_16x16x32_bf16 v[52:55], a[100:103], v[132:135], v[52:55]
  v_mfma_f32_16x16x32_bf16 v[56:59], a[104:107], v[132:135], v[56:59]
  v_mfma_f32_16x16x32_bf16 v[60:63], a[108:111], v[132:135], v[60:63]
  s_add_u32 s81, s80, 57344
  buffer_load_dwordx4 v[116:119], v3, s[8:11], s81 offen sc1
  s_waitcnt vmcnt(11)
  v_mfma_f32_16x16x32_bf16 v[64:67], a[96:99], v[136:139], v[64:67]
  v_mfma_f32_16x16x32_bf16 v[68:71], a[100:103], v[136:139], v[68:71]
  v_mfma_f32_16x16x32_bf16 v[72:75], a[104:107], v[136:139], v[72:75]
  v_mfma_f32_16x16x32_bf16 v[76:79], a[108:111], v[136:139], v[76:79]
  s_add_u32 s80, s75, s73
  buffer_load_dwordx4 v[120:123], v3, s[8:11], s80 offen sc1
  s_waitcnt vmcnt(11)
  v_mfma_f32_16x16x32_bf16 v[80:83], a[96:99], v[140:143], v[80:83]
  v_mfma_f32_16x16x32_bf16 v[84:87], a[100:103], v[140:143], v[84:87]
  v_mfma_f32_16x16x32_bf16 v[88:91], a[104:107], v[140:143], v[88:91]
  v_mfma_f32_16x16x32_bf16 v[92:95], a[108:111], v[140:143], v[92:95]
  s_add_u32 s81, s80, 57344
  buffer_load_dwordx4 v[124:127], v3, s[8:11], s81 offen sc1
  s_add_u32 s73, s73, 1024
  s_cmp_eq_u32 s73, 14336
  s_cselect_b32 s73, 0, s73
  s_waitcnt vmcnt(11)
  v_mfma_f32_16x16x32_bf16 v[32:35], a[112:115], v[144:147], v[32:35]
  v_mfma_f32_16x16x32_bf16 v[36:39], a[116:119], v[144:147], v[36:39]
  v_mfma_f32_16x16x32_bf16 v[40:43], a[120:123], v[144:147], v[40:43]
  v_mfma_f32_16x16x32_bf16 v[44:47], a[124:127], v[144:147], v[44:47]
  s_add_u32 s80, s72, s73
  buffer_load_dwordx4 v[128:131], v3, s[8:11], s80 offen sc1
  s_waitcnt vmcnt(11)
  v_mfma_f32_16x16x32_bf16 v[48:51], a[112:115], v[148:151], v[48:51]
  v_mfma_f32_16x16x32_bf16 v[52:55], a[116:119], v[148:151], v[52:55]
  v_mfma_f32_16x16x32_bf16 v[56:59], a[120:123], v[148:151], v[56:59]
  v_mfma_f32_16x16x32_bf16 v[60:63], a[124:127], v[148:151], v[60:63]
  s_add_u32 s81, s80, 57344
  buffer_load_dwordx4 v[132:135], v3, s[8:11], s81 offen sc1
  s_waitcnt vmcnt(11)
  v_mfma_f32_16x16x32_bf16 v[64:67], a[112:115], v[152:155], v[64:67]
  v_mfma_f32_16x16x32_bf16 v[68:71], a[116:119], v[152:155], v[68:71]
  v_mfma_f32_16x16x32_bf16 v[72:75], a[120:123], v[152:155], v[72:75]
  v_mfma_f32_16x16x32_bf16 v[76:79], a[124:127], v[152:155], v[76:79]
  s_add_u32 s80, s75, s73
  buffer_load_dwordx4 v[136:139], v3, s[8:11], s80 offen sc1
  s_waitcnt vmcnt(11)
  v_mfma_f32_16x16x32_bf16 v[80:83], a[112:115], v[156:159], v[80:83]
  v_mfma_f32_16x16x32_bf16 v[84:87], a[116:119], v[156:159], v[84:87]
  v_mfma_f32_16x16x32_bf16 v[88:91], a[120:123], v[156:159], v[88:91]
  v_mfma_f32_16x16x32_bf16 v[92:95], a[124:127], v[156:159], v[92:95]
  s_add_u32 s81, s80, 57344
  buffer_load_dwordx4 v[140:143], v3, s[8:11], s81 offen sc1
  s_add_u32 s73, s73, 1024
  s_cmp_eq_u32 s73, 14336
  s_cselect_b32 s73, 0, s73
  s_waitcnt vmcnt(11)
  v_mfma_f32_16x16x32_bf16 v[32:35], a[128:131], v[96:99], v[32:35]
  v_mfma_f32_16x16x32_bf16 v[36:39], a[132:135], v[96:99], v[36:39]
  v_mfma_f32_16x16x32_bf16 v[40:43], a[136:139], v[96:99], v[40:43]
  v_mfma_f32_16x16x32_bf16 v[44:47], a[140:143], v[96:99], v[44:47]
  s_add_u32 s80, s72, s73
  buffer_load_dwordx4 v[144:147], v3, s[8:11], s80 offen sc1
  s_waitcnt vmcnt(11)
  v_mfma_f32_16x16x32_bf16 v[48:51], a[128:131], v[100:103], v[48:51]
  v_mfma_f32_16x16x32_bf16 v[52:55], a[132:135], v[100:103], v[52:55]
  v_mfma_f32_16x16x32_bf16 v[56:59], a[136:139], v[100:103], v[56:59]
  v_mfma_f32_16x16x32_bf16 v[60:63], a[140:143], v[100:103], v[60:63]
  s_add_u32 s81, s80, 57344
  buffer_load_dwordx4 v[148:151], v3, s[8:11], s81 offen sc1
  s_waitcnt vmcnt(11)
  v_mfma_f32_16x16x32_bf16 v[64:67], a[128:131], v[104:107], v[64:67]
  v_mfma_f32_16x16x32_bf16 v[68:71], a[132:135], v[104:107], v[68:71]
  v_mfma_f32_16x16x32_bf16 v[72:75], a[136:139], v[104:107], v[72:75]
  v_mfma_f32_16x16x32_bf16 v[76:79], a[140:143], v[104:107], v[76:79]
  s_add_u32 s80, s75, s73
  buffer_load_dwordx4 v[152:155], v3, s[8:11], s80 offen sc1
  s_waitcnt vmcnt(11)
  v_mfma_f32_16x16x32_bf16 v[80:83], a[128:131], v[108:111], v[80:83]
  v_mfma_f32_16x16x32_bf16 v[84:87], a[132:135], v[108:111], v[84:87]
  v_mfma_f32_16x16x32_bf16 v[88:91], a[136:139], v[108:111], v[88:91]
  v_mfma_f32_16x16x32_bf16 v[92:95], a[140:143], v[108:111], v[92:95]
  s_add_u32 s81, s80, 57344
  buffer_load_dwordx4 v[156:159], v3, s[8:11], s81 offen sc1
  s_add_u32 s73, s73, 1024
  s_cmp_eq_u32 s73, 14336
  s_cselect_b32 s73, 0, s73
  s_waitcnt vmcnt(11)
  v_mfma_f32_16x16x32_bf16 v[32:35], a[144:147], v[112:115], v[32:35]
  v_mfma_f32_16x16x32_bf16 v[36:39], a[148:151], v[112:115], v[36:39]
  v_mfma_f32_16x16x32_bf16 v[40:43], a[152:155], v[112:115], v[40:43]
  v_mfma_f32_16x16x32_bf16 v[44:47], a[156:159], v[112:115], v[44:47]
  s_add_u32 s80, s72, s73
  buffer_load_dwordx4 v[96:99], v3, s[8:11], s80 offen sc1
  s_waitcnt vmcnt(11)
  v_mfma_f32_16x16x32_bf16 v[48:51], a[144:147], v[116:119], v[48:51]
  v_mfma_f32_16x16x32_bf16 v[52:55], a[148:151], v[116:119], v[52:55]
  v_mfma_f32_16x16x32_bf16 v[56:59], a[152:155], v[116:119], v[56:59]
  v_mfma_f32_16x16x32_bf16 v[60:63], a[156:159], v[116:119], v[60:63]
  s_add_u32 s81, s80, 57344
  buffer_load_dwordx4 v[100:103], v3, s[8:11], s81 offen sc1
  s_waitcnt vmcnt(11)
  v_mfma_f32_16x16x32_bf16 v[64:67], a[144:147], v[120:123], v[64:67]
  v_mfma_f32_16x16x32_bf16 v[68:71], a[148:151], v[120:123], v[68:71]
  v_mfma_f32_16x16x32_bf16 v[72:75], a[152:155], v[120:123], v[72:75]
  v_mfma_f32_16x16x32_bf16 v[76:79], a[156:159], v[120:123], v[76:79]
  s_add_u32 s80, s75, s73
  buffer_load_dwordx4 v[104:107], v3, s[8:11], s80 offen sc1
  s_waitcnt vmcnt(11)
  v_mfma_f32_16x16x32_bf16 v[80:83], a[144:147], v[124:127], v[80:83]
  v_mfma_f32_16x16x32_bf16 v[84:87], a[148:151], v[124:127], v[84:87]
  v_mfma_f32_16x16x32_bf16 v[88:91], a[152:155], v[124:127], v[88:91]
  v_mfma_f32_16x16x32_bf16 v[92:95], a[156:159], v[124:127], v[92:95]
  s_add_u32 s81, s80, 57344
  buffer_load_dwordx4 v[108:111], v3, s[8:11], s81 offen sc1
  s_add_u32 s73, s73, 1024
  s_cmp_eq_u32 s73, 14336
  s_cselect_b32 s73, 0, s73
  s_waitcnt vmcnt(11)
  v_mfma_f32_16x16x32_bf16 v[32:35], a[160:163], v[128:131], v[32:35]
  v_mfma_f32_16x16x32_bf16 v[36:39], a[164:167], v[128:131], v[36:39]
  v_mfma_f32_16x16x32_bf16 v[40:43], a[168:171], v[128:131], v[40:43]
  v_mfma_f32_16x16x32_bf16 v[44:47], a[172:175], v[128:131], v[44:47]
  s_add_u32 s80, s72, s73
  buffer_load_dwordx4 v[112:115], v3, s[8:11], s80 offen sc1
  s_waitcnt vmcnt(11)
  v_mfma_f32_16x16x32_bf16 v[48:51], a[160:163], v[132:135], v[48:51]
  v_mfma_f32_16x16x32_bf16 v[52:55], a[164:167], v[132:135], v[52:55]
  v_mfma_f32_16x16x32_bf16 v[56:59], a[168:171], v[132:135], v[56:59]
  v_mfma_f32_16x16x32_bf16 v[60:63], a[172:175], v[132:135], v[60:63]
  s_add_u32 s81, s80, 57344
  buffer_load_dwordx4 v[116:119], v3, s[8:11], s81 offen sc1
  s_waitcnt vmcnt(11)
  v_mfma_f32_16x16x32_bf16 v[64:67], a[160:163], v[136:139], v[64:67]
  v_mfma_f32_16x16x32_bf16 v[68:71], a[164:167], v[136:139], v[68:71]
  v_mfma_f32_16x16x32_bf16 v[72:75], a[168:171], v[136:139], v[72:75]
  v_mfma_f32_16x16x32_bf16 v[76:79], a[172:175], v[136:139], v[76:79]
  s_add_u32 s80, s75, s73
  buffer_load_dwordx4 v[120:123], v3, s[8:11], s80 offen sc1
  s_waitcnt vmcnt(11)
  v_mfma_f32_16x16x32_bf16 v[80:83], a[160:163], v[140:143], v[80:83]
  v_mfma_f32_16x16x32_bf16 v[84:87], a[164:167], v[140:143], v[84:87]
  v_mfma_f32_16x16x32_bf16 v[88:91], a[168:171], v[140:143], v[88:91]
  v_mfma_f32_16x16x32_bf16 v[92:95], a[172:175], v[140:143], v[92:95]
  s_add_u32 s81, s80, 57344
  buffer_load_dwordx4 v[124:127], v3, s[8:11], s81 offen sc1
  s_add_u32 s73, s73, 1024
  s_cmp_eq_u32 s73, 14336
  s_cselect_b32 s73, 0, s73
  s_waitcnt vmcnt(11)
  v_mfma_f32_16x16x32_bf16 v[32:35], a[176:179], v[144:147], v[32:35]
  v_mfma_f32_16x16x32_bf16 v[36:39], a[180:183], v[144:147], v[36:39]
  v_mfma_f32_16x16x32_bf16 v[40:43], a[184:187], v[144:147], v[40:43]
  v_mfma_f32_16x16x32_bf16 v[44:47], a[188:191], v[144:147], v[44:47]
  s_waitcnt vmcnt(10)
  v_mfma_f32_16x16x32_bf16 v[48:51], a[176:179], v[148:151], v[48:51]
  v_mfma_f32_16x16x32_bf16 v[52:55], a[180:183], v[148:151], v[52:55]
  v_mfma_f32_16x16x32_bf16 v[56:59], a[184:187], v[148:151], v[56:59]
  v_mfma_f32_16x16x32_bf16 v[60:63], a[188:191], v[148:151], v[60:63]
  s_waitcnt vmcnt(9)
  v_mfma_f32_16x16x32_bf16 v[64:67], a[176:179], v[152:155], v[64:67]
  v_mfma_f32_16x16x32_bf16 v[68:71], a[180:183], v[152:155], v[68:71]
  v_mfma_f32_16x16x32_bf16 v[72:75], a[184:187], v[152:155], v[72:75]
  v_mfma_f32_16x16x32_bf16 v[76:79], a[188:191], v[152:155], v[76:79]
  s_waitcnt vmcnt(8)
  v_mfma_f32_16x16x32_bf16 v[80:83], a[176:179], v[156:159], v[80:83]
  v_mfma_f32_16x16x32_bf16 v[84:87], a[180:183], v[156:159], v[84:87]
  v_mfma_f32_16x16x32_bf16 v[88:91], a[184:187], v[156:159], v[88:91]
  v_mfma_f32_16x16x32_bf16 v[92:95], a[188:191], v[156:159], v[92:95]
  s_waitcnt vmcnt(7)
  v_mfma_f32_16x16x32_bf16 v[32:35], a[192:195], v[96:99], v[32:35]
  v_mfma_f32_16x16x32_bf16 v[36:39], a[196:199], v[96:99], v[36:39]
  v_mfma_f32_16x16x32_bf16 v[40:43], a[200:203], v[96:99], v[40:43]
  v_mfma_f32_16x16x32_bf16 v[44:47], a[204:207], v[96:99], v[44:47]
  buffer_load_dwordx4 v[160:163], v9, s[20:23], 0 offen sc1
  buffer_load_dwordx4 v[164:167], v9, s[20:23], 0 offen offset:16 sc1
  s_waitcnt vmcnt(8)
  v_mfma_f32_16x16x32_bf16 v[48:51], a[192:195], v[100:103], v[48:51]
  v_mfma_f32_16x16x32_bf16 v[52:55], a[196:199], v[100:103], v[52:55]
  v_mfma_f32_16x16x32_bf16 v[56:59], a[200:203], v[100:103], v[56:59]
  v_mfma_f32_16x16x32_bf16 v[60:63], a[204:207], v[100:103], v[60:63]
  s_waitcnt vmcnt(7)
  v_mfma_f32_16x16x32_bf16 v[64:67], a[192:195], v[104:107], v[64:67]
  v_mfma_f32_16x16x32_bf16 v[68:71], a[196:199], v[104:107], v[68:71]
  v_mfma_f32_16x16x32_bf16 v[72:75], a[200:203], v[104:107], v[72:75]
  v_mfma_f32_16x16x32_bf16 v[76:79], a[204:207], v[104:107], v[76:79]
  s_waitcnt vmcnt(6)
  v_mfma_f32_16x16x32_bf16 v[80:83], a[192:195], v[108:111], v[80:83]
  v_mfma_f32_16x16x32_bf16 v[84:87], a[196:199], v[108:111], v[84:87]
  v_mfma_f32_16x16x32_bf16 v[88:91], a[200:203], v[108:111], v[88:91]
  v_mfma_f32_16x16x32_bf16 v[92:95], a[204:207], v[108:111], v[92:95]
  s_waitcnt vmcnt(5)
  v_mfma_f32_16x16x32_bf16 v[32:35], a[208:211], v[112:115], v[32:35]
  v_mfma_f32_16x16x32_bf16 v[36:39], a[212:215], v[112:115], v[36:39]
  v_mfma_f32_16x16x32_bf16 v[40:43], a[216:219], v[112:115], v[40:43]
  v_mfma_f32_16x16x32_bf16 v[44:47], a[220:223], v[112:115], v[44:47]
  s_waitcnt vmcnt(4)
  v_mfma_f32_16x16x32_bf16 v[48:51], a[208:211], v[116:119], v[48:51]
  v_mfma_f32_16x16x32_bf16 v[52:55], a[212:215], v[116:119], v[52:55]
  v_mfma_f32_16x16x32_bf16 v[56:59], a[216:219], v[116:119], v[56:59]
  v_mfma_f32_16x16x32_bf16 v[60:63], a[220:223], v[116:119], v[60:63]
  s_waitcnt vmcnt(3)
  v_mfma_f32_16x16x32_bf16 v[64:67], a[208:211], v[120:123], v[64:67]
  v_mfma_f32_16x16x32_bf16 v[68:71], a[212:215], v[120:123], v[68:71]
  v_mfma_f32_16x16x32_bf16 v[72:75], a[216:219], v[120:123], v[72:75]
  v_mfma_f32_16x16x32_bf16 v[76:79], a[220:223], v[120:123], v[76:79]
  s_waitcnt vmcnt(2)
  v_mfma_f32_16x16x32_bf16 v[80:83], a[208:211], v[124:127], v[80:83]
  v_mfma_f32_16x16x32_bf16 v[84:87], a[212:215], v[124:127], v[84:87]
  v_mfma_f32_16x16x32_bf16 v[88:91], a[216:219], v[124:127], v[88:91]
  v_mfma_f32_16x16x32_bf16 v[92:95], a[220:223], v[124:127], v[92:95]
  ds_write_b128 v10, v[32:35] offset:0
  ds_write_b128 v10, v[36:39] offset:16
  ds_write_b128 v10, v[40:43] offset:32
  ds_write_b128 v10, v[44:47] offset:48
  ds_write_b128 v10, v[48:51] offset:4352
  ds_write_b128 v10, v[52:55] offset:4368
  ds_write_b128 v10, v[56:59] offset:4384
  ds_write_b128 v10, v[60:63] offset:4400
  s_waitcnt lgkmcnt(4)
  ds_write_b128 v10, v[64:67] offset:8704
  ds_write_b128 v10, v[68:71] offset:8720
  ds_write_b128 v10, v[72:75] offset:8736
  ds_write_b128 v10, v[76:79] offset:8752
  ds_write_b128 v10, v[80:83] offset:13056
  ds_write_b128 v10, v[84:87] offset:13072
  ds_write_b128 v10, v[88:91] offset:13088
  ds_write_b128 v10, v[92:95] offset:13104
  s_waitcnt lgkmcnt(4)
  s_waitcnt vmcnt(0)
  v_lshlrev_b32 v168, 16, v160
  v_and_b32 v169, 0xffff0000, v160
  v_lshlrev_b32 v170, 16, v161
  v_and_b32 v171, 0xffff0000, v161
  v_lshlrev_b32 v172, 16, v162
  v_and_b32 v173, 0xffff0000, v162
  v_lshlrev_b32 v174, 16, v163
  v_and_b32 v175, 0xffff0000, v163
  v_lshlrev_b32 v176, 16, v164
  v_and_b32 v177, 0xffff0000, v164
  v_lshlrev_b32 v178, 16, v165
  v_and_b32 v179, 0xffff0000, v165
  v_lshlrev_b32 v180, 16, v166
  v_and_b32 v181, 0xffff0000, v166
  v_lshlrev_b32 v182, 16, v167
  v_and_b32 v183, 0xffff0000, v167
  s_waitcnt lgkmcnt(0)
  s_barrier
  ds_read_b128 v[32:35], v11 offset:0
  ds_read_b128 v[36:39], v11 offset:16
  ds_read_b128 v[40:43], v11 offset:32
  ds_read_b128 v[44:47], v11 offset:48
  ds_read_b128 v[48:51], v11 offset:17408
  ds_read_b128 v[52:55], v11 offset:17424
  ds_read_b128 v[56:59], v11 offset:17440
  ds_read_b128 v[60:63], v11 offset:17456
  ds_read_b128 v[64:67], v11 offset:34816
  ds_read_b128 v[68:71], v11 offset:34832
  ds_read_b128 v[72:75], v11 offset:34848
  ds_read_b128 v[76:79], v11 offset:34864
  s_waitcnt lgkmcnt(8)
  ds_read_b128 v[80:83], v11 offset:52224
  ds_read_b128 v[84:87], v11 offset:52240
  ds_read_b128 v[88:91], v11 offset:52256
  ds_read_b128 v[92:95], v11 offset:52272
  s_waitcnt lgkmcnt(8)
  v_pk_add_f32 v[32:33], v[32:33], v[48:49]
  v_pk_add_f32 v[34:35], v[34:35], v[50:51]
  v_pk_add_f32 v[36:37], v[36:37], v[52:53]
  v_pk_add_f32 v[38:39], v[38:39], v[54:55]
  v_pk_add_f32 v[40:41], v[40:41], v[56:57]
  v_pk_add_f32 v[42:43], v[42:43], v[58:59]
  v_pk_add_f32 v[44:45], v[44:45], v[60:61]
  v_pk_add_f32 v[46:47], v[46:47], v[62:63]
  s_waitcnt lgkmcnt(0)
  v_pk_add_f32 v[64:65], v[64:65], v[80:81]
  v_pk_add_f32 v[66:67], v[66:67], v[82:83]
  v_pk_add_f32 v[68:69], v[68:69], v[84:85]
  v_pk_add_f32 v[70:71], v[70:71], v[86:87]
  v_pk_add_f32 v[72:73], v[72:73], v[88:89]
  v_pk_add_f32 v[74:75], v[74:75], v[90:91]
  v_pk_add_f32 v[76:77], v[76:77], v[92:93]
  v_pk_add_f32 v[78:79], v[78:79], v[94:95]
  v_pk_add_f32 v[32:33], v[32:33], v[64:65]
  v_pk_add_f32 v[34:35], v[34:35], v[66:67]
  v_pk_add_f32 v[36:37], v[36:37], v[68:69]
  v_pk_add_f32 v[38:39], v[38:39], v[70:71]
  v_pk_add_f32 v[40:41], v[40:41], v[72:73]
  v_pk_add_f32 v[42:43], v[42:43], v[74:75]
  v_pk_add_f32 v[44:45], v[44:45], v[76:77]
  v_pk_add_f32 v[46:47], v[46:47], v[78:79]
  v_fmac_f32 v168, v16, v32
  v_fmac_f32 v169, v17, v36
  v_fmac_f32 v170, v18, v40
  v_fmac_f32 v171, v19, v44
  v_fmac_f32 v172, v20, v33
  v_fmac_f32 v173, v21, v37
  v_fmac_f32 v174, v22, v41
  v_fmac_f32 v175, v23, v45
  v_fmac_f32 v176, v24, v34
  v_fmac_f32 v177, v25, v38
  v_fmac_f32 v178, v26, v42
  v_fmac_f32 v179, v27, v46
  v_fmac_f32 v180, v28, v35
  v_fmac_f32 v181, v29, v39
  v_fmac_f32 v182, v30, v43
  v_fmac_f32 v183, v31, v47
  v_cvt_pk_bf16_f32 v64, v168, v169
  v_cvt_pk_bf16_f32 v65, v170, v171
  v_cvt_pk_bf16_f32 v66, v172, v173
  v_cvt_pk_bf16_f32 v67, v174, v175
  v_cvt_pk_bf16_f32 v68, v176, v177
  v_cvt_pk_bf16_f32 v69, v178, v179
  v_cvt_pk_bf16_f32 v70, v180, v181
  v_cvt_pk_bf16_f32 v71, v182, v183
  buffer_store_dwordx4 v[64:67], v9, s[20:23], 0 offen
  buffer_store_dwordx4 v[68:71], v9, s[20:23], 0 offen offset:16
  s_cmp_lg_u32 s2, 0
  s_cbranch_scc1 adaLN_cond__spectral_fnet__dense_activation_relu__prompt_kernel_noe
  s_cmp_lg_u32 s33, 0
  s_cbranch_scc1 adaLN_cond__spectral_fnet__dense_activation_relu__prompt_kernel_noe
  s_add_u32 s60, s100, 1
  v_mov_b32 v5, s60
  v_mov_b32 v6, 0
  s_mov_b32 s61, 8491008
  s_mov_b64 exec, 1
  buffer_store_dword v5, v6, s[8:11], s61 offen
  s_mov_b64 exec, -1
adaLN_cond__spectral_fnet__dense_activation_relu__prompt_kernel_noe:
adaLN_cond__spectral_fnet__dense_activation_relu__prompt_kernel_exit:
  s_endpgm

.section .rodata,"a"
.p2align 6
.amdhsa_kernel adaLN_cond__spectral_fnet__dense_activation_relu__prompt_kernel
  .amdhsa_next_free_vgpr 512
  .amdhsa_next_free_sgpr 102
  .amdhsa_accum_offset 256
  .amdhsa_group_segment_fixed_size 0
  .amdhsa_kernarg_size 104
  .amdhsa_user_sgpr_count 2
  .amdhsa_user_sgpr_kernarg_segment_ptr 1
  .amdhsa_system_sgpr_workgroup_id_x 1
.end_amdhsa_kernel
.text
.p2align 8
.type fnet_tables,@object
fnet_tables:
  .long 0x3f800000,0x3f800000,0x3f800000,0x3f800000,0x3f800000,0x3f800000,0x3f800000,0x3f800000
  .long 0x3f800000,0xbf800000,0x3f800000,0xbf800000,0x3f800000,0xbf800000,0x3f800000,0xbf800000
  .long 0x3f800000,0x3f7b14be,0x3f6c835e,0x3f54db31,0xbf800000,0xbf7b14be,0xbf6c835e,0xbf54db31
  .long 0x80000000,0xbe47c5c2,0xbec3ef15,0xbf0e39da,0xa50d3132,0x3e47c5c2,0x3ec3ef15,0x3f0e39da
  .long 0x3f800000,0x3f6c835e,0x3f3504f3,0x3ec3ef15,0x3f800000,0x3f6c835e,0x3f3504f3,0x3ec3ef15
  .long 0x80000000,0xbec3ef15,0xbf3504f3,0xbf6c835e,0x80000000,0xbec3ef15,0xbf3504f3,0xbf6c835e
  .long 0x3f800000,0x3f54db31,0x3ec3ef15,0xbe47c5c2,0xbf800000,0xbf54db31,0xbec3ef15,0x3e47c5c2
  .long 0x80000000,0xbf0e39da,0xbf6c835e,0xbf7b14be,0xa50d3132,0x3f0e39da,0x3f6c835e,0x3f7b14be
  .long 0x3f800000,0x3f3504f3,0x248d3132,0xbf3504f3,0x3f800000,0x3f3504f3,0x248d3132,0xbf3504f3
  .long 0x80000000,0xbf3504f3,0xbf800000,0xbf3504f3,0x80000000,0xbf3504f3,0xbf800000,0xbf3504f3
  .long 0x3f800000,0x3f0e39da,0xbec3ef15,0xbf7b14be,0xbf800000,0xbf0e39da,0x3ec3ef15,0x3f7b14be
  .long 0x80000000,0xbf54db31,0xbf6c835e,0xbe47c5c2,0xa50d3132,0x3f54db31,0x3f6c835e,0x3e47c5c2
  .long 0x3f800000,0x3ec3ef15,0xbf3504f3,0xbf6c835e,0x3f800000,0x3ec3ef15,0xbf3504f3,0xbf6c835e
  .long 0x80000000,0xbf6c835e,0xbf3504f3,0x3ec3ef15,0x80000000,0xbf6c835e,0xbf3504f3,0x3ec3ef15
  .long 0x3f800000,0x3e47c5c2,0xbf6c835e,0xbf0e39da,0xbf800000,0xbe47c5c2,0x3f6c835e,0x3f0e39da
  .long 0x80000000,0xbf7b14be,0xbec3ef15,0x3f54db31,0xa50d3132,0x3f7b14be,0x3ec3ef15,0xbf54db31
  .long 0x3f800000,0x3f800000,0x3f800000,0x3f800000,0x3f800000,0x3f800000,0x3f800000,0x3f800000
  .long 0x3f800000,0xbf800000,0x3f800000,0xbf800000,0x3f800000,0xbf800000,0x3f800000,0xbf800000
  .long 0x3f3504f3,0x3f0e39da,0x3ec3ef15,0x3e47c5c2,0xbf3504f3,0xbf0e39da,0xbec3ef15,0xbe47c5c2
  .long 0xbf3504f3,0xbf54db31,0xbf6c835e,0xbf7b14be,0x3f3504f3,0x3f54db31,0x3f6c835e,0x3f7b14be
  .long 0x248d3132,0xbec3ef15,0xbf3504f3,0xbf6c835e,0x248d3132,0xbec3ef15,0xbf3504f3,0xbf6c835e
  .long 0xbf800000,0xbf6c835e,0xbf3504f3,0xbec3ef15,0xbf800000,0xbf6c835e,0xbf3504f3,0xbec3ef15
  .long 0xbf3504f3,0xbf7b14be,0xbf6c835e,0xbf0e39da,0x3f3504f3,0x3f7b14be,0x3f6c835e,0x3f0e39da
  .long 0xbf3504f3,0xbe47c5c2,0x3ec3ef15,0x3f54db31,0x3f3504f3,0x3e47c5c2,0xbec3ef15,0xbf54db31
  .long 0xbf800000,0xbf3504f3,0xa553c9ca,0x3f3504f3,0xbf800000,0xbf3504f3,0xa553c9ca,0x3f3504f3
  .long 0xa50d3132,0x3f3504f3,0x3f800000,0x3f3504f3,0xa50d3132,0x3f3504f3,0x3f800000,0x3f3504f3
  .long 0xbf3504f3,0x3e47c5c2,0x3f6c835e,0x3f54db31,0x3f3504f3,0xbe47c5c2,0xbf6c835e,0xbf54db31
  .long 0x3f3504f3,0x3f7b14be,0x3ec3ef15,0xbf0e39da,0xbf3504f3,0xbf7b14be,0xbec3ef15,0x3f0e39da
  .long 0xa553c9ca,0x3f6c835e,0x3f3504f3,0xbec3ef15,0xa553c9ca,0x3f6c835e,0x3f3504f3,0xbec3ef15
  .long 0x3f800000,0x3ec3ef15,0xbf3504f3,0xbf6c835e,0x3f800000,0x3ec3ef15,0xbf3504f3,0xbf6c835e
  .long 0x3f3504f3,0x3f54db31,0xbec3ef15,0xbf7b14be,0xbf3504f3,0xbf54db31,0x3ec3ef15,0x3f7b14be
  .long 0x3f3504f3,0xbf0e39da,0xbf6c835e,0x3e47c5c2,0xbf3504f3,0x3f0e39da,0x3f6c835e,0xbe47c5c2
  .long 0x3f800000,0x3f800000,0x3f800000,0x3f800000,0x3f800000,0x3f800000,0x3f800000,0x3f800000
  .long 0x3f800000,0xbf800000,0x3f800000,0xbf800000,0x3f800000,0xbf800000,0x3f800000,0xbf800000
  .long 0x248d3132,0xbe47c5c2,0xbec3ef15,0xbf0e39da,0xa553c9ca,0x3e47c5c2,0x3ec3ef15,0x3f0e39da
  .long 0xbf800000,0xbf7b14be,0xbf6c835e,0xbf54db31,0x3f800000,0x3f7b14be,0x3f6c835e,0x3f54db31
  .long 0xbf800000,0xbf6c835e,0xbf3504f3,0xbec3ef15,0xbf800000,0xbf6c835e,0xbf3504f3,0xbec3ef15
  .long 0xa50d3132,0x3ec3ef15,0x3f3504f3,0x3f6c835e,0xa50d3132,0x3ec3ef15,0x3f3504f3,0x3f6c835e
  .long 0xa553c9ca,0x3f0e39da,0x3f6c835e,0x3f7b14be,0x248d3132,0xbf0e39da,0xbf6c835e,0xbf7b14be
  .long 0x3f800000,0x3f54db31,0x3ec3ef15,0xbe47c5c2,0xbf800000,0xbf54db31,0xbec3ef15,0x3e47c5c2
  .long 0x3f800000,0x3f3504f3,0x248d3132,0xbf3504f3,0x3f800000,0x3f3504f3,0x248d3132,0xbf3504f3
  .long 0x80000000,0xbf3504f3,0xbf800000,0xbf3504f3,0x80000000,0xbf3504f3,0xbf800000,0xbf3504f3
  .long 0x248d3132,0xbf54db31,0xbf6c835e,0xbe47c5c2,0xa553c9ca,0x3f54db31,0x3f6c835e,0x3e47c5c2
  .long 0xbf800000,0xbf0e39da,0x3ec3ef15,0x3f7b14be,0x3f800000,0x3f0e39da,0xbec3ef15,0xbf7b14be
  .long 0xbf800000,0xbec3ef15,0x3f3504f3,0x3f6c835e,0xbf800000,0xbec3ef15,0x3f3504f3,0x3f6c835e
  .long 0xa50d3132,0x3f6c835e,0x3f3504f3,0xbec3ef15,0xa50d3132,0x3f6c835e,0x3f3504f3,0xbec3ef15
  .long 0xa553c9ca,0x3f7b14be,0x3ec3ef15,0xbf54db31,0x248d3132,0xbf7b14be,0xbec3ef15,0x3f54db31
  .long 0x3f800000,0x3e47c5c2,0xbf6c835e,0xbf0e39da,0xbf800000,0xbe47c5c2,0x3f6c835e,0x3f0e39da
  .long 0x3f800000,0x3f800000,0x3f800000,0x3f800000,0x3f800000,0x3f800000,0x3f800000,0x3f800000
  .long 0x3f800000,0xbf800000,0x3f800000,0xbf800000,0x3f800000,0xbf800000,0x3f800000,0xbf800000
  .long 0xbf3504f3,0xbf54db31,0xbf6c835e,0xbf7b14be,0x3f3504f3,0x3f54db31,0x3f6c835e,0x3f7b14be
  .long 0xbf3504f3,0xbf0e39da,0xbec3ef15,0xbe47c5c2,0x3f3504f3,0x3f0e39da,0x3ec3ef15,0x3e47c5c2
  .long 0xa553c9ca,0x3ec3ef15,0x3f3504f3,0x3f6c835e,0xa553c9ca,0x3ec3ef15,0x3f3504f3,0x3f6c835e
  .long 0x3f800000,0x3f6c835e,0x3f3504f3,0x3ec3ef15,0x3f800000,0x3f6c835e,0x3f3504f3,0x3ec3ef15
  .long 0x3f3504f3,0x3e47c5c2,0xbec3ef15,0xbf54db31,0xbf3504f3,0xbe47c5c2,0x3ec3ef15,0x3f54db31
  .long 0xbf3504f3,0xbf7b14be,0xbf6c835e,0xbf0e39da,0x3f3504f3,0x3f7b14be,0x3f6c835e,0x3f0e39da
  .long 0xbf800000,0xbf3504f3,0xa553c9ca,0x3f3504f3,0xbf800000,0xbf3504f3,0xa553c9ca,0x3f3504f3
  .long 0xa50d3132,0x3f3504f3,0x3f800000,0x3f3504f3,0xa50d3132,0x3f3504f3,0x3f800000,0x3f3504f3
  .long 0x3f3504f3,0x3f7b14be,0x3ec3ef15,0xbf0e39da,0xbf3504f3,0xbf7b14be,0xbec3ef15,0x3f0e39da
  .long 0x3f3504f3,0xbe47c5c2,0xbf6c835e,0xbf54db31,0xbf3504f3,0x3e47c5c2,0x3f6c835e,0x3f54db31
  .long 0x248d3132,0xbf6c835e,0xbf3504f3,0x3ec3ef15,0x248d3132,0xbf6c835e,0xbf3504f3,0x3ec3ef15
  .long 0xbf800000,0xbec3ef15,0x3f3504f3,0x3f6c835e,0xbf800000,0xbec3ef15,0x3f3504f3,0x3f6c835e
  .long 0xbf3504f3,0x3f0e39da,0x3f6c835e,0xbe47c5c2,0x3f3504f3,0xbf0e39da,0xbf6c835e,0x3e47c5c2
  .long 0x3f3504f3,0x3f54db31,0xbec3ef15,0xbf7b14be,0xbf3504f3,0xbf54db31,0x3ec3ef15,0x3f7b14be
  .long 0x3f800000,0x248d3132,0xbf800000,0xa553c9ca,0x3f800000,0x248d3132,0xbf800000,0xa553c9ca
  .long 0x80000000,0xbf800000,0xa50d3132,0x3f800000,0x80000000,0xbf800000,0xa50d3132,0x3f800000
  .long 0x3f800000,0xbe47c5c2,0xbf6c835e,0x3f0e39da,0xbf800000,0x3e47c5c2,0x3f6c835e,0xbf0e39da
  .long 0x80000000,0xbf7b14be,0x3ec3ef15,0x3f54db31,0xa50d3132,0x3f7b14be,0xbec3ef15,0xbf54db31
  .long 0x3f800000,0xbec3ef15,0xbf3504f3,0x3f6c835e,0x3f800000,0xbec3ef15,0xbf3504f3,0x3f6c835e
  .long 0x80000000,0xbf6c835e,0x3f3504f3,0x3ec3ef15,0x80000000,0xbf6c835e,0x3f3504f3,0x3ec3ef15
  .long 0x3f800000,0xbf0e39da,0xbec3ef15,0x3f7b14be,0xbf800000,0x3f0e39da,0x3ec3ef15,0xbf7b14be
  .long 0x80000000,0xbf54db31,0x3f6c835e,0xbe47c5c2,0xa50d3132,0x3f54db31,0xbf6c835e,0x3e47c5c2
  .long 0x3f800000,0xbf3504f3,0xa553c9ca,0x3f3504f3,0x3f800000,0xbf3504f3,0xa553c9ca,0x3f3504f3
  .long 0x80000000,0xbf3504f3,0x3f800000,0xbf3504f3,0x80000000,0xbf3504f3,0x3f800000,0xbf3504f3
  .long 0x3f800000,0xbf54db31,0x3ec3ef15,0x3e47c5c2,0xbf800000,0x3f54db31,0xbec3ef15,0xbe47c5c2
  .long 0x80000000,0xbf0e39da,0x3f6c835e,0xbf7b14be,0xa50d3132,0x3f0e39da,0xbf6c835e,0x3f7b14be
  .long 0x3f800000,0xbf6c835e,0x3f3504f3,0xbec3ef15,0x3f800000,0xbf6c835e,0x3f3504f3,0xbec3ef15
  .long 0x80000000,0xbec3ef15,0x3f3504f3,0xbf6c835e,0x80000000,0xbec3ef15,0x3f3504f3,0xbf6c835e
  .long 0x3f800000,0xbf7b14be,0x3f6c835e,0xbf54db31,0xbf800000,0x3f7b14be,0xbf6c835e,0x3f54db31
  .long 0x80000000,0xbe47c5c2,0x3ec3ef15,0xbf0e39da,0xa50d3132,0x3e47c5c2,0xbec3ef15,0x3f0e39da
  .long 0x3f800000,0x248d3132,0xbf800000,0xa553c9ca,0x3f800000,0x248d3132,0xbf800000,0xa553c9ca
  .long 0x80000000,0xbf800000,0xa50d3132,0x3f800000,0x80000000,0xbf800000,0xa50d3132,0x3f800000
  .long 0x3f3504f3,0xbf54db31,0xbec3ef15,0x3f7b14be,0xbf3504f3,0x3f54db31,0x3ec3ef15,0xbf7b14be
  .long 0xbf3504f3,0xbf0e39da,0x3f6c835e,0x3e47c5c2,0x3f3504f3,0x3f0e39da,0xbf6c835e,0xbe47c5c2
  .long 0x248d3132,0xbf6c835e,0x3f3504f3,0x3ec3ef15,0x248d3132,0xbf6c835e,0x3f3504f3,0x3ec3ef15
  .long 0xbf800000,0x3ec3ef15,0x3f3504f3,0xbf6c835e,0xbf800000,0x3ec3ef15,0x3f3504f3,0xbf6c835e
  .long 0xbf3504f3,0xbe47c5c2,0x3f6c835e,0xbf54db31,0x3f3504f3,0x3e47c5c2,0xbf6c835e,0x3f54db31
  .long 0xbf3504f3,0x3f7b14be,0xbec3ef15,0xbf0e39da,0x3f3504f3,0xbf7b14be,0x3ec3ef15,0x3f0e39da
  .long 0xbf800000,0x3f3504f3,0x248d3132,0xbf3504f3,0xbf800000,0x3f3504f3,0x248d3132,0xbf3504f3
  .long 0xa50d3132,0x3f3504f3,0xbf800000,0x3f3504f3,0xa50d3132,0x3f3504f3,0xbf800000,0x3f3504f3
  .long 0xbf3504f3,0x3f7b14be,0xbf6c835e,0x3f0e39da,0x3f3504f3,0xbf7b14be,0x3f6c835e,0xbf0e39da
  .long 0x3f3504f3,0xbe47c5c2,0xbec3ef15,0x3f54db31,0xbf3504f3,0x3e47c5c2,0x3ec3ef15,0xbf54db31
  .long 0xa553c9ca,0x3ec3ef15,0xbf3504f3,0x3f6c835e,0xa553c9ca,0x3ec3ef15,0xbf3504f3,0x3f6c835e
  .long 0x3f800000,0xbf6c835e,0x3f3504f3,0xbec3ef15,0x3f800000,0xbf6c835e,0x3f3504f3,0xbec3ef15
  .long 0x3f3504f3,0xbf0e39da,0x3ec3ef15,0xbe47c5c2,0xbf3504f3,0x3f0e39da,0xbec3ef15,0x3e47c5c2
  .long 0x3f3504f3,0xbf54db31,0x3f6c835e,0xbf7b14be,0xbf3504f3,0x3f54db31,0xbf6c835e,0x3f7b14be
  .long 0x3f800000,0x248d3132,0xbf800000,0xa553c9ca,0x3f800000,0x248d3132,0xbf800000,0xa553c9ca
  .long 0x80000000,0xbf800000,0xa50d3132,0x3f800000,0x80000000,0xbf800000,0xa50d3132,0x3f800000
  .long 0x248d3132,0xbf7b14be,0x3ec3ef15,0x3f54db31,0xa553c9ca,0x3f7b14be,0xbec3ef15,0xbf54db31
  .long 0xbf800000,0x3e47c5c2,0x3f6c835e,0xbf0e39da,0x3f800000,0xbe47c5c2,0xbf6c835e,0x3f0e39da
  .long 0xbf800000,0x3ec3ef15,0x3f3504f3,0xbf6c835e,0xbf800000,0x3ec3ef15,0x3f3504f3,0xbf6c835e
  .long 0xa50d3132,0x3f6c835e,0xbf3504f3,0xbec3ef15,0xa50d3132,0x3f6c835e,0xbf3504f3,0xbec3ef15
  .long 0xa553c9ca,0x3f54db31,0xbf6c835e,0x3e47c5c2,0x248d3132,0xbf54db31,0x3f6c835e,0xbe47c5c2
  .long 0x3f800000,0xbf0e39da,0xbec3ef15,0x3f7b14be,0xbf800000,0x3f0e39da,0x3ec3ef15,0xbf7b14be
  .long 0x3f800000,0xbf3504f3,0xa553c9ca,0x3f3504f3,0x3f800000,0xbf3504f3,0xa553c9ca,0x3f3504f3
  .long 0x80000000,0xbf3504f3,0x3f800000,0xbf3504f3,0x80000000,0xbf3504f3,0x3f800000,0xbf3504f3
  .long 0x248d3132,0xbf0e39da,0x3f6c835e,0xbf7b14be,0xa553c9ca,0x3f0e39da,0xbf6c835e,0x3f7b14be
  .long 0xbf800000,0x3f54db31,0xbec3ef15,0xbe47c5c2,0x3f800000,0xbf54db31,0x3ec3ef15,0x3e47c5c2
  .long 0xbf800000,0x3f6c835e,0xbf3504f3,0x3ec3ef15,0xbf800000,0x3f6c835e,0xbf3504f3,0x3ec3ef15
  .long 0xa50d3132,0x3ec3ef15,0xbf3504f3,0x3f6c835e,0xa50d3132,0x3ec3ef15,0xbf3504f3,0x3f6c835e
  .long 0xa553c9ca,0x3e47c5c2,0xbec3ef15,0x3f0e39da,0x248d3132,0xbe47c5c2,0x3ec3ef15,0xbf0e39da
  .long 0x3f800000,0xbf7b14be,0x3f6c835e,0xbf54db31,0xbf800000,0x3f7b14be,0xbf6c835e,0x3f54db31
  .long 0x3f800000,0x248d3132,0xbf800000,0xa553c9ca,0x3f800000,0x248d3132,0xbf800000,0xa553c9ca
  .long 0x80000000,0xbf800000,0xa50d3132,0x3f800000,0x80000000,0xbf800000,0xa50d3132,0x3f800000
  .long 0xbf3504f3,0xbf0e39da,0x3f6c835e,0x3e47c5c2,0x3f3504f3,0x3f0e39da,0xbf6c835e,0xbe47c5c2
  .long 0xbf3504f3,0x3f54db31,0x3ec3ef15,0xbf7b14be,0x3f3504f3,0xbf54db31,0xbec3ef15,0x3f7b14be
  .long 0xa553c9ca,0x3f6c835e,0xbf3504f3,0xbec3ef15,0xa553c9ca,0x3f6c835e,0xbf3504f3,0xbec3ef15
  .long 0x3f800000,0xbec3ef15,0xbf3504f3,0x3f6c835e,0x3f800000,0xbec3ef15,0xbf3504f3,0x3f6c835e
  .long 0x3f3504f3,0xbf7b14be,0x3ec3ef15,0x3f0e39da,0xbf3504f3,0x3f7b14be,0xbec3ef15,0xbf0e39da
  .long 0xbf3504f3,0xbe47c5c2,0x3f6c835e,0xbf54db31,0x3f3504f3,0x3e47c5c2,0xbf6c835e,0x3f54db31
  .long 0xbf800000,0x3f3504f3,0x248d3132,0xbf3504f3,0xbf800000,0x3f3504f3,0x248d3132,0xbf3504f3
  .long 0xa50d3132,0x3f3504f3,0xbf800000,0x3f3504f3,0xa50d3132,0x3f3504f3,0xbf800000,0x3f3504f3
  .long 0x3f3504f3,0xbe47c5c2,0xbec3ef15,0x3f54db31,0xbf3504f3,0x3e47c5c2,0x3ec3ef15,0xbf54db31
  .long 0x3f3504f3,0xbf7b14be,0x3f6c835e,0xbf0e39da,0xbf3504f3,0x3f7b14be,0xbf6c835e,0x3f0e39da
  .long 0x248d3132,0xbec3ef15,0x3f3504f3,0xbf6c835e,0x248d3132,0xbec3ef15,0x3f3504f3,0xbf6c835e
  .long 0xbf800000,0x3f6c835e,0xbf3504f3,0x3ec3ef15,0xbf800000,0x3f6c835e,0xbf3504f3,0x3ec3ef15
  .long 0xbf3504f3,0x3f54db31,0xbf6c835e,0x3f7b14be,0x3f3504f3,0xbf54db31,0x3f6c835e,0xbf7b14be
  .long 0x3f3504f3,0xbf0e39da,0x3ec3ef15,0xbe47c5c2,0xbf3504f3,0x3f0e39da,0xbec3ef15,0x3e47c5c2
  .long 0x3f803f80,0x3f803f80,0x3f803f80,0x3f803f80,0x3f7b3f80,0x3f553f6d,0xbf7bbf80,0xbf55bf6d
  .long 0x3f6d3f80,0x3ec43f35,0x3f6d3f80,0x3ec43f35,0x3f553f80,0xbe483ec4,0xbf55bf80,0x3e48bec4
  .long 0x3f353f80,0xbf35248d,0x3f353f80,0xbf35248d,0x3f0e3f80,0xbf7bbec4,0xbf0ebf80,0x3f7b3ec4
  .long 0x3ec43f80,0xbf6dbf35,0x3ec43f80,0xbf6dbf35,0x3e483f80,0xbf0ebf6d,0xbe48bf80,0x3f0e3f6d
  .long 0x248d3f80,0xa554bf80,0x248d3f80,0xa554bf80,0xbe483f80,0x3f0ebf6d,0x3e48bf80,0xbf0e3f6d
  .long 0xbec43f80,0x3f6dbf35,0xbec43f80,0x3f6dbf35,0xbf0e3f80,0x3f7bbec4,0x3f0ebf80,0xbf7b3ec4
  .long 0xbf353f80,0x3f35a554,0xbf353f80,0x3f35a554,0xbf553f80,0x3e483ec4,0x3f55bf80,0xbe48bec4
  .long 0xbf6d3f80,0xbec43f35,0xbf6d3f80,0xbec43f35,0xbf7b3f80,0xbf553f6d,0x3f7bbf80,0x3f55bf6d
  .long 0x3f803f80,0x3f803f80,0x3f803f80,0x3f803f80,0x3f0e3f35,0x3e483ec4,0xbf0ebf35,0xbe48bec4
  .long 0xbec4248d,0xbf6dbf35,0xbec4248d,0xbf6dbf35,0xbf7bbf35,0xbf0ebf6d,0x3f7b3f35,0x3f0e3f6d
  .long 0xbf35bf80,0x3f35a554,0xbf35bf80,0x3f35a554,0x3e48bf35,0x3f553f6d,0xbe483f35,0xbf55bf6d
  .long 0x3f6da554,0xbec43f35,0x3f6da554,0xbec43f35,0x3f553f35,0xbf7bbec4,0xbf55bf35,0x3f7b3ec4
  .long 0x248d3f80,0xa554bf80,0x248d3f80,0xa554bf80,0xbf553f35,0x3f7bbec4,0x3f55bf35,0xbf7b3ec4
  .long 0xbf6d248d,0x3ec43f35,0xbf6d248d,0x3ec43f35,0xbe48bf35,0xbf553f6d,0x3e483f35,0x3f55bf6d
  .long 0x3f35bf80,0xbf35248d,0x3f35bf80,0xbf35248d,0x3f7bbf35,0x3f0ebf6d,0xbf7b3f35,0xbf0e3f6d
  .long 0x3ec4a554,0x3f6dbf35,0x3ec4a554,0x3f6dbf35,0xbf0e3f35,0xbe483ec4,0x3f0ebf35,0x3e48bec4
  .long 0x3f803f80,0x3f803f80,0x3f803f80,0x3f803f80,0xbe48248d,0xbf0ebec4,0x3e48a554,0x3f0e3ec4
  .long 0xbf6dbf80,0xbec4bf35,0xbf6dbf80,0xbec4bf35,0x3f0ea554,0x3f7b3f6d,0xbf0e248d,0xbf7bbf6d
  .long 0x3f353f80,0xbf35248d,0x3f353f80,0xbf35248d,0xbf55248d,0xbe48bf6d,0x3f55a554,0x3e483f6d
  .long 0xbec4bf80,0x3f6d3f35,0xbec4bf80,0x3f6d3f35,0x3f7ba554,0xbf553ec4,0xbf7b248d,0x3f55bec4
  .long 0x248d3f80,0xa554bf80,0x248d3f80,0xa554bf80,0xbf7b248d,0x3f553ec4,0x3f7ba554,0xbf55bec4
  .long 0x3ec4bf80,0xbf6d3f35,0x3ec4bf80,0xbf6d3f35,0x3f55a554,0x3e48bf6d,0xbf55248d,0xbe483f6d
  .long 0xbf353f80,0x3f35a554,0xbf353f80,0x3f35a554,0xbf0e248d,0xbf7b3f6d,0x3f0ea554,0x3f7bbf6d
  .long 0x3f6dbf80,0x3ec4bf35,0x3f6dbf80,0x3ec4bf35,0x3e48a554,0x3f0ebec4,0xbe48248d,0xbf0e3ec4
  .long 0x3f803f80,0x3f803f80,0x3f803f80,0x3f803f80,0xbf55bf35,0xbf7bbf6d,0x3f553f35,0x3f7b3f6d
  .long 0x3ec4a554,0x3f6d3f35,0x3ec4a554,0x3f6d3f35,0x3e483f35,0xbf55bec4,0xbe48bf35,0x3f553ec4
  .long 0xbf35bf80,0x3f35a554,0xbf35bf80,0x3f35a554,0x3f7b3f35,0xbf0e3ec4,0xbf7bbf35,0x3f0ebec4
  .long 0xbf6d248d,0x3ec4bf35,0xbf6d248d,0x3ec4bf35,0x3f0ebf35,0xbe483f6d,0xbf0e3f35,0x3e48bf6d
  .long 0x248d3f80,0xa554bf80,0x248d3f80,0xa554bf80,0xbf0ebf35,0x3e483f6d,0x3f0e3f35,0xbe48bf6d
  .long 0x3f6da554,0xbec4bf35,0x3f6da554,0xbec4bf35,0xbf7b3f35,0x3f0e3ec4,0x3f7bbf35,0xbf0ebec4
  .long 0x3f35bf80,0xbf35248d,0x3f35bf80,0xbf35248d,0xbe483f35,0x3f55bec4,0x3e48bf35,0xbf553ec4
  .long 0xbec4248d,0xbf6d3f35,0xbec4248d,0xbf6d3f35,0x3f55bf35,0x3f7bbf6d,0xbf553f35,0xbf7b3f6d
  .long 0x00000000,0x00000000,0x00000000,0x00000000,0x3e480000,0x3f0e3ec4,0xbe48250d,0xbf0ebec4
  .long 0x3ec40000,0x3f6d3f35,0x3ec40000,0x3f6d3f35,0x3f0e0000,0x3f7b3f6d,0xbf0e250d,0xbf7bbf6d
  .long 0x3f350000,0x3f353f80,0x3f350000,0x3f353f80,0x3f550000,0x3e483f6d,0xbf55250d,0xbe48bf6d
  .long 0x3f6d0000,0xbec43f35,0x3f6d0000,0xbec43f35,0x3f7b0000,0xbf553ec4,0xbf7b250d,0x3f55bec4
  .long 0x3f800000,0xbf80250d,0x3f800000,0xbf80250d,0x3f7b0000,0xbf55bec4,0xbf7b250d,0x3f553ec4
  .long 0x3f6d0000,0xbec4bf35,0x3f6d0000,0xbec4bf35,0x3f550000,0x3e48bf6d,0xbf55250d,0xbe483f6d
  .long 0x3f350000,0x3f35bf80,0x3f350000,0x3f35bf80,0x3f0e0000,0x3f7bbf6d,0xbf0e250d,0xbf7b3f6d
  .long 0x3ec40000,0x3f6dbf35,0x3ec40000,0x3f6dbf35,0x3e480000,0x3f0ebec4,0xbe48250d,0xbf0e3ec4
  .long 0x00000000,0x00000000,0x00000000,0x00000000,0x3f553f35,0x3f7b3f6d,0xbf55bf35,0xbf7bbf6d
  .long 0x3f6d3f80,0x3ec43f35,0x3f6d3f80,0x3ec43f35,0x3e483f35,0xbf55bec4,0xbe48bf35,0x3f553ec4
  .long 0xbf35250d,0xbf35bf80,0xbf35250d,0xbf35bf80,0xbf7bbf35,0x3f0ebec4,0x3f7b3f35,0xbf0e3ec4
  .long 0xbec4bf80,0x3f6d3f35,0xbec4bf80,0x3f6d3f35,0x3f0ebf35,0xbe483f6d,0xbf0e3f35,0x3e48bf6d
  .long 0x3f800000,0xbf80250d,0x3f800000,0xbf80250d,0x3f0e3f35,0xbe48bf6d,0xbf0ebf35,0x3e483f6d
  .long 0xbec43f80,0x3f6dbf35,0xbec43f80,0x3f6dbf35,0xbf7b3f35,0x3f0e3ec4,0x3f7bbf35,0xbf0ebec4
  .long 0xbf35250d,0xbf353f80,0xbf35250d,0xbf353f80,0x3e48bf35,0xbf553ec4,0xbe483f35,0x3f55bec4
  .long 0x3f6dbf80,0x3ec4bf35,0x3f6dbf80,0x3ec4bf35,0x3f55bf35,0x3f7bbf6d,0xbf553f35,0xbf7b3f6d
  .long 0x00000000,0x00000000,0x00000000,0x00000000,0x3f7b3f80,0x3f553f6d,0xbf7bbf80,0xbf55bf6d
  .long 0xbec4250d,0xbf6dbf35,0xbec4250d,0xbf6dbf35,0xbf55bf80,0x3e48bec4,0x3f553f80,0xbe483ec4
  .long 0x3f350000,0x3f353f80,0x3f350000,0x3f353f80,0x3f0e3f80,0xbf7bbec4,0xbf0ebf80,0x3f7b3ec4
  .long 0xbf6d250d,0x3ec4bf35,0xbf6d250d,0x3ec4bf35,0xbe48bf80,0x3f0e3f6d,0x3e483f80,0xbf0ebf6d
  .long 0x3f800000,0xbf80250d,0x3f800000,0xbf80250d,0xbe483f80,0x3f0ebf6d,0x3e48bf80,0xbf0e3f6d
  .long 0xbf6d250d,0x3ec43f35,0xbf6d250d,0x3ec43f35,0x3f0ebf80,0xbf7b3ec4,0xbf0e3f80,0x3f7bbec4
  .long 0x3f350000,0x3f35bf80,0x3f350000,0x3f35bf80,0xbf553f80,0x3e483ec4,0x3f55bf80,0xbe48bec4
  .long 0xbec4250d,0xbf6d3f35,0xbec4250d,0xbf6d3f35,0x3f7bbf80,0x3f55bf6d,0xbf7b3f80,0xbf553f6d
  .long 0x00000000,0x00000000,0x00000000,0x00000000,0x3f0e3f35,0x3e483ec4,0xbf0ebf35,0xbe48bec4
  .long 0xbf6dbf80,0xbec4bf35,0xbf6dbf80,0xbec4bf35,0x3f7b3f35,0x3f0e3f6d,0xbf7bbf35,0xbf0ebf6d
  .long 0xbf35250d,0xbf35bf80,0xbf35250d,0xbf35bf80,0x3e48bf35,0x3f553f6d,0xbe483f35,0xbf55bf6d
  .long 0x3ec43f80,0xbf6dbf35,0x3ec43f80,0xbf6dbf35,0xbf55bf35,0x3f7b3ec4,0x3f553f35,0xbf7bbec4
  .long 0x3f800000,0xbf80250d,0x3f800000,0xbf80250d,0xbf553f35,0x3f7bbec4,0x3f55bf35,0xbf7b3ec4
  .long 0x3ec4bf80,0xbf6d3f35,0x3ec4bf80,0xbf6d3f35,0x3e483f35,0x3f55bf6d,0xbe48bf35,0xbf553f6d
  .long 0xbf35250d,0xbf353f80,0xbf35250d,0xbf353f80,0x3f7bbf35,0x3f0ebf6d,0xbf7b3f35,0xbf0e3f6d
  .long 0xbf6d3f80,0xbec43f35,0xbf6d3f80,0xbec43f35,0x3f0ebf35,0x3e48bec4,0xbf0e3f35,0xbe483ec4
  .long 0xbf803f80,0xbf803f80,0xbf803f80,0xbf803f80,0xbf7b3f80,0xbf553f6d,0x3f7bbf80,0x3f55bf6d
  .long 0xbf6d3f80,0xbec43f35,0xbf6d3f80,0xbec43f35,0xbf553f80,0x3e483ec4,0x3f55bf80,0xbe48bec4
  .long 0xbf353f80,0x3f35248d,0xbf353f80,0x3f35248d,0xbf0e3f80,0x3f7bbec4,0x3f0ebf80,0xbf7b3ec4
  .long 0xbec43f80,0x3f6dbf35,0xbec43f80,0x3f6dbf35,0xbe483f80,0x3f0ebf6d,0x3e48bf80,0xbf0e3f6d
  .long 0xa5543f80,0x248dbf80,0xa5543f80,0x248dbf80,0x3e483f80,0xbf0ebf6d,0xbe48bf80,0x3f0e3f6d
  .long 0x3ec43f80,0xbf6dbf35,0x3ec43f80,0xbf6dbf35,0x3f0e3f80,0xbf7bbec4,0xbf0ebf80,0x3f7b3ec4
  .long 0x3f353f80,0xbf35a554,0x3f353f80,0xbf35a554,0x3f553f80,0xbe483ec4,0xbf55bf80,0x3e48bec4
  .long 0x3f6d3f80,0x3ec43f35,0x3f6d3f80,0x3ec43f35,0x3f7b3f80,0x3f553f6d,0xbf7bbf80,0xbf55bf6d
  .long 0xbf803f80,0xbf803f80,0xbf803f80,0xbf803f80,0xbf0e3f35,0xbe483ec4,0x3f0ebf35,0x3e48bec4
  .long 0x3ec4248d,0x3f6dbf35,0x3ec4248d,0x3f6dbf35,0x3f7bbf35,0x3f0ebf6d,0xbf7b3f35,0xbf0e3f6d
  .long 0x3f35bf80,0xbf35a554,0x3f35bf80,0xbf35a554,0xbe48bf35,0xbf553f6d,0x3e483f35,0x3f55bf6d
  .long 0xbf6da554,0x3ec43f35,0xbf6da554,0x3ec43f35,0xbf553f35,0x3f7bbec4,0x3f55bf35,0xbf7b3ec4
  .long 0xa5543f80,0x248dbf80,0xa5543f80,0x248dbf80,0x3f553f35,0xbf7bbec4,0xbf55bf35,0x3f7b3ec4
  .long 0x3f6d248d,0xbec43f35,0x3f6d248d,0xbec43f35,0x3e48bf35,0x3f553f6d,0xbe483f35,0xbf55bf6d
  .long 0xbf35bf80,0x3f35248d,0xbf35bf80,0x3f35248d,0xbf7bbf35,0xbf0ebf6d,0x3f7b3f35,0x3f0e3f6d
  .long 0xbec4a554,0xbf6dbf35,0xbec4a554,0xbf6dbf35,0x3f0e3f35,0x3e483ec4,0xbf0ebf35,0xbe48bec4
  .long 0xbf803f80,0xbf803f80,0xbf803f80,0xbf803f80,0x3e48248d,0x3f0ebec4,0xbe48a554,0xbf0e3ec4
  .long 0x3f6dbf80,0x3ec4bf35,0x3f6dbf80,0x3ec4bf35,0xbf0ea554,0xbf7b3f6d,0x3f0e248d,0x3f7bbf6d
  .long 0xbf353f80,0x3f35248d,0xbf353f80,0x3f35248d,0x3f55248d,0x3e48bf6d,0xbf55a554,0xbe483f6d
  .long 0x3ec4bf80,0xbf6d3f35,0x3ec4bf80,0xbf6d3f35,0xbf7ba554,0x3f553ec4,0x3f7b248d,0xbf55bec4
  .long 0xa5543f80,0x248dbf80,0xa5543f80,0x248dbf80,0x3f7b248d,0xbf553ec4,0xbf7ba554,0x3f55bec4
  .long 0xbec4bf80,0x3f6d3f35,0xbec4bf80,0x3f6d3f35,0xbf55a554,0xbe48bf6d,0x3f55248d,0x3e483f6d
  .long 0x3f353f80,0xbf35a554,0x3f353f80,0xbf35a554,0x3f0e248d,0x3f7b3f6d,0xbf0ea554,0xbf7bbf6d
  .long 0xbf6dbf80,0xbec4bf35,0xbf6dbf80,0xbec4bf35,0xbe48a554,0xbf0ebec4,0x3e48248d,0x3f0e3ec4
  .long 0xbf803f80,0xbf803f80,0xbf803f80,0xbf803f80,0x3f55bf35,0x3f7bbf6d,0xbf553f35,0xbf7b3f6d
  .long 0xbec4a554,0xbf6d3f35,0xbec4a554,0xbf6d3f35,0xbe483f35,0x3f55bec4,0x3e48bf35,0xbf553ec4
  .long 0x3f35bf80,0xbf35a554,0x3f35bf80,0xbf35a554,0xbf7b3f35,0x3f0e3ec4,0x3f7bbf35,0xbf0ebec4
  .long 0x3f6d248d,0xbec4bf35,0x3f6d248d,0xbec4bf35,0xbf0ebf35,0x3e483f6d,0x3f0e3f35,0xbe48bf6d
  .long 0xa5543f80,0x248dbf80,0xa5543f80,0x248dbf80,0x3f0ebf35,0xbe483f6d,0xbf0e3f35,0x3e48bf6d
  .long 0xbf6da554,0x3ec4bf35,0xbf6da554,0x3ec4bf35,0x3f7b3f35,0xbf0e3ec4,0xbf7bbf35,0x3f0ebec4
  .long 0xbf35bf80,0x3f35248d,0xbf35bf80,0x3f35248d,0x3e483f35,0xbf55bec4,0xbe48bf35,0x3f553ec4
  .long 0x3ec4248d,0x3f6d3f35,0x3ec4248d,0x3f6d3f35,0xbf55bf35,0xbf7bbf6d,0x3f553f35,0x3f7b3f6d
  .long 0x250d0000,0x250d0000,0x250d0000,0x250d0000,0xbe480000,0xbf0e3ec4,0x3e48250d,0x3f0ebec4
  .long 0xbec40000,0xbf6d3f35,0xbec40000,0xbf6d3f35,0xbf0e0000,0xbf7b3f6d,0x3f0e250d,0x3f7bbf6d
  .long 0xbf350000,0xbf353f80,0xbf350000,0xbf353f80,0xbf550000,0xbe483f6d,0x3f55250d,0x3e48bf6d
  .long 0xbf6d0000,0x3ec43f35,0xbf6d0000,0x3ec43f35,0xbf7b0000,0x3f553ec4,0x3f7b250d,0xbf55bec4
  .long 0xbf800000,0x3f80250d,0xbf800000,0x3f80250d,0xbf7b0000,0x3f55bec4,0x3f7b250d,0xbf553ec4
  .long 0xbf6d0000,0x3ec4bf35,0xbf6d0000,0x3ec4bf35,0xbf550000,0xbe48bf6d,0x3f55250d,0x3e483f6d
  .long 0xbf350000,0xbf35bf80,0xbf350000,0xbf35bf80,0xbf0e0000,0xbf7bbf6d,0x3f0e250d,0x3f7b3f6d
  .long 0xbec40000,0xbf6dbf35,0xbec40000,0xbf6dbf35,0xbe480000,0xbf0ebec4,0x3e48250d,0x3f0e3ec4
  .long 0x250d0000,0x250d0000,0x250d0000,0x250d0000,0xbf553f35,0xbf7b3f6d,0x3f55bf35,0x3f7bbf6d
  .long 0xbf6d3f80,0xbec43f35,0xbf6d3f80,0xbec43f35,0xbe483f35,0x3f55bec4,0x3e48bf35,0xbf553ec4
  .long 0x3f35250d,0x3f35bf80,0x3f35250d,0x3f35bf80,0x3f7bbf35,0xbf0ebec4,0xbf7b3f35,0x3f0e3ec4
  .long 0x3ec4bf80,0xbf6d3f35,0x3ec4bf80,0xbf6d3f35,0xbf0ebf35,0x3e483f6d,0x3f0e3f35,0xbe48bf6d
  .long 0xbf800000,0x3f80250d,0xbf800000,0x3f80250d,0xbf0e3f35,0x3e48bf6d,0x3f0ebf35,0xbe483f6d
  .long 0x3ec43f80,0xbf6dbf35,0x3ec43f80,0xbf6dbf35,0x3f7b3f35,0xbf0e3ec4,0xbf7bbf35,0x3f0ebec4
  .long 0x3f35250d,0x3f353f80,0x3f35250d,0x3f353f80,0xbe48bf35,0x3f553ec4,0x3e483f35,0xbf55bec4
  .long 0xbf6dbf80,0xbec4bf35,0xbf6dbf80,0xbec4bf35,0xbf55bf35,0xbf7bbf6d,0x3f553f35,0x3f7b3f6d
  .long 0x250d0000,0x250d0000,0x250d0000,0x250d0000,0xbf7b3f80,0xbf553f6d,0x3f7bbf80,0x3f55bf6d
  .long 0x3ec4250d,0x3f6dbf35,0x3ec4250d,0x3f6dbf35,0x3f55bf80,0xbe48bec4,0xbf553f80,0x3e483ec4
  .long 0xbf350000,0xbf353f80,0xbf350000,0xbf353f80,0xbf0e3f80,0x3f7bbec4,0x3f0ebf80,0xbf7b3ec4
  .long 0x3f6d250d,0xbec4bf35,0x3f6d250d,0xbec4bf35,0x3e48bf80,0xbf0e3f6d,0xbe483f80,0x3f0ebf6d
  .long 0xbf800000,0x3f80250d,0xbf800000,0x3f80250d,0x3e483f80,0xbf0ebf6d,0xbe48bf80,0x3f0e3f6d
  .long 0x3f6d250d,0xbec43f35,0x3f6d250d,0xbec43f35,0xbf0ebf80,0x3f7b3ec4,0x3f0e3f80,0xbf7bbec4
  .long 0xbf350000,0xbf35bf80,0xbf350000,0xbf35bf80,0x3f553f80,0xbe483ec4,0xbf55bf80,0x3e48bec4
  .long 0x3ec4250d,0x3f6d3f35,0x3ec4250d,0x3f6d3f35,0xbf7bbf80,0xbf55bf6d,0x3f7b3f80,0x3f553f6d
  .long 0x250d0000,0x250d0000,0x250d0000,0x250d0000,0xbf0e3f35,0xbe483ec4,0x3f0ebf35,0x3e48bec4
  .long 0x3f6dbf80,0x3ec4bf35,0x3f6dbf80,0x3ec4bf35,0xbf7b3f35,0xbf0e3f6d,0x3f7bbf35,0x3f0ebf6d
  .long 0x3f35250d,0x3f35bf80,0x3f35250d,0x3f35bf80,0xbe48bf35,0xbf553f6d,0x3e483f35,0x3f55bf6d
  .long 0xbec43f80,0x3f6dbf35,0xbec43f80,0x3f6dbf35,0x3f55bf35,0xbf7b3ec4,0xbf553f35,0x3f7bbec4
  .long 0xbf800000,0x3f80250d,0xbf800000,0x3f80250d,0x3f553f35,0xbf7bbec4,0xbf55bf35,0x3f7b3ec4
  .long 0xbec4bf80,0x3f6d3f35,0xbec4bf80,0x3f6d3f35,0xbe483f35,0xbf55bf6d,0x3e48bf35,0x3f553f6d
  .long 0x3f35250d,0x3f353f80,0x3f35250d,0x3f353f80,0xbf7bbf35,0xbf0ebf6d,0x3f7b3f35,0x3f0e3f6d
  .long 0x3f6d3f80,0x3ec43f35,0x3f6d3f80,0x3ec43f35,0xbf0ebf35,0xbe48bec4,0x3f0e3f35,0x3e483ec4
  .long 0x3f800000,0x3f800000,0x3f800000,0x3f800000,0x3f800000,0x3f7fb10f,0x3f7ec46d,0x3f7d3aac
  .long 0x3f800000,0x3f7ec46d,0x3f7b14be,0x3f74fa0b,0x3f800000,0x3f7d3aac,0x3f74fa0b,0x3f676bd8
  .long 0x3f800000,0x3f800000,0x3f800000,0x3f800000,0x3f3504f3,0x3f2beb4a,0x3f226799,0x3f187fc0
  .long 0x248d3132,0xbdc8bd36,0xbe47c5c2,0xbe94a031,0xbf3504f3,0xbf4d9f02,0xbf61c598,0xbf710908
  .long 0x00000000,0x00000000,0x00000000,0x00000000,0x00000000,0x3d48fb30,0x3dc8bd36,0x3e164083
  .long 0x00000000,0x3dc8bd36,0x3e47c5c2,0x3e94a031,0x00000000,0x3e164083,0x3e94a031,0x3edae880
  .long 0x00000000,0x00000000,0x00000000,0x00000000,0x3f3504f3,0x3f3daef9,0x3f45e403,0x3f4d9f02
  .long 0x3f800000,0x3f7ec46d,0x3f7b14be,0x3f74fa0b,0x3f3504f3,0x3f187fc0,0x3ef15aea,0x3eac7cd4
  .long 0x3f800000,0x3f800000,0x3f800000,0x3f800000,0x3f800000,0x3f7fb10f,0x3f7ec46d,0x3f7d3aac
  .long 0x3f800000,0x3f7ec46d,0x3f7b14be,0x3f74fa0b,0x3f800000,0x3f7d3aac,0x3f74fa0b,0x3f676bd8
  .long 0x3f800000,0x3f800000,0x3f800000,0x3f800000,0x3f3504f3,0x3f2beb4a,0x3f226799,0x3f187fc0
  .long 0x248d3132,0xbdc8bd36,0xbe47c5c2,0xbe94a031,0xbf3504f3,0xbf4d9f02,0xbf61c598,0xbf710908
  .long 0x80000000,0x80000000,0x80000000,0x80000000,0x80000000,0xbd48fb30,0xbdc8bd36,0xbe164083
  .long 0x80000000,0xbdc8bd36,0xbe47c5c2,0xbe94a031,0x80000000,0xbe164083,0xbe94a031,0xbedae880
  .long 0x80000000,0x80000000,0x80000000,0x80000000,0xbf3504f3,0xbf3daef9,0xbf45e403,0xbf4d9f02
  .long 0xbf800000,0xbf7ec46d,0xbf7b14be,0xbf74fa0b,0xbf3504f3,0xbf187fc0,0xbef15aea,0xbeac7cd4
  .long 0x3f800000,0x3f800000,0x3f800000,0x3f800000,0x3f7b14be,0x3f7853f8,0x3f74fa0b,0x3f710908
  .long 0x3f6c835e,0x3f61c598,0x3f54db31,0x3f45e403,0x3f54db31,0x3f3daef9,0x3f226799,0x3f039c3d
  .long 0x3f800000,0x3f800000,0x3f800000,0x3f800000,0x3f0e39da,0x3f039c3d,0x3ef15aea,0x3edae880
  .long 0xbec3ef15,0xbef15aea,0xbf0e39da,0xbf226799,0xbf7b14be,0xbf7fb10f,0xbf7ec46d,0xbf7853f8
  .long 0x00000000,0x00000000,0x00000000,0x00000000,0x3e47c5c2,0x3e78cfcc,0x3e94a031,0x3eac7cd4
  .long 0x3ec3ef15,0x3ef15aea,0x3f0e39da,0x3f226799,0x3f0e39da,0x3f2beb4a,0x3f45e403,0x3f5b941a
  .long 0x00000000,0x00000000,0x00000000,0x00000000,0x3f54db31,0x3f5b941a,0x3f61c598,0x3f676bd8
  .long 0x3f6c835e,0x3f61c598,0x3f54db31,0x3f45e403,0x3e47c5c2,0x3d48fb30,0xbdc8bd36,0xbe78cfcc
  .long 0x3f800000,0x3f800000,0x3f800000,0x3f800000,0x3f7b14be,0x3f7853f8,0x3f74fa0b,0x3f710908
  .long 0x3f6c835e,0x3f61c598,0x3f54db31,0x3f45e403,0x3f54db31,0x3f3daef9,0x3f226799,0x3f039c3d
  .long 0x3f800000,0x3f800000,0x3f800000,0x3f800000,0x3f0e39da,0x3f039c3d,0x3ef15aea,0x3edae880
  .long 0xbec3ef15,0xbef15aea,0xbf0e39da,0xbf226799,0xbf7b14be,0xbf7fb10f,0xbf7ec46d,0xbf7853f8
  .long 0x80000000,0x80000000,0x80000000,0x80000000,0xbe47c5c2,0xbe78cfcc,0xbe94a031,0xbeac7cd4
  .long 0xbec3ef15,0xbef15aea,0xbf0e39da,0xbf226799,0xbf0e39da,0xbf2beb4a,0xbf45e403,0xbf5b941a
  .long 0x80000000,0x80000000,0x80000000,0x80000000,0xbf54db31,0xbf5b941a,0xbf61c598,0xbf676bd8
  .long 0xbf6c835e,0xbf61c598,0xbf54db31,0xbf45e403,0xbe47c5c2,0xbd48fb30,0x3dc8bd36,0x3e78cfcc
  .long 0x3f800000,0x3f800000,0x3f800000,0x3f800000,0x3f6c835e,0x3f676bd8,0x3f61c598,0x3f5b941a
  .long 0x3f3504f3,0x3f226799,0x3f0e39da,0x3ef15aea,0x3ec3ef15,0x3e78cfcc,0x3dc8bd36,0xbd48fb30
  .long 0x3f800000,0x3f800000,0x3f800000,0x3f800000,0x3ec3ef15,0x3eac7cd4,0x3e94a031,0x3e78cfcc
  .long 0xbf3504f3,0xbf45e403,0xbf54db31,0xbf61c598,0xbf6c835e,0xbf5b941a,0xbf45e403,0xbf2beb4a
  .long 0x00000000,0x00000000,0x00000000,0x00000000,0x3ec3ef15,0x3edae880,0x3ef15aea,0x3f039c3d
  .long 0x3f3504f3,0x3f45e403,0x3f54db31,0x3f61c598,0x3f6c835e,0x3f7853f8,0x3f7ec46d,0x3f7fb10f
  .long 0x00000000,0x00000000,0x00000000,0x00000000,0x3f6c835e,0x3f710908,0x3f74fa0b,0x3f7853f8
  .long 0x3f3504f3,0x3f226799,0x3f0e39da,0x3ef15aea,0xbec3ef15,0xbf039c3d,0xbf226799,0xbf3daef9
  .long 0x3f800000,0x3f800000,0x3f800000,0x3f800000,0x3f6c835e,0x3f676bd8,0x3f61c598,0x3f5b941a
  .long 0x3f3504f3,0x3f226799,0x3f0e39da,0x3ef15aea,0x3ec3ef15,0x3e78cfcc,0x3dc8bd36,0xbd48fb30
  .long 0x3f800000,0x3f800000,0x3f800000,0x3f800000,0x3ec3ef15,0x3eac7cd4,0x3e94a031,0x3e78cfcc
  .long 0xbf3504f3,0xbf45e403,0xbf54db31,0xbf61c598,0xbf6c835e,0xbf5b941a,0xbf45e403,0xbf2beb4a
  .long 0x80000000,0x80000000,0x80000000,0x80000000,0xbec3ef15,0xbedae880,0xbef15aea,0xbf039c3d
  .long 0xbf3504f3,0xbf45e403,0xbf54db31,0xbf61c598,0xbf6c835e,0xbf7853f8,0xbf7ec46d,0xbf7fb10f
  .long 0x80000000,0x80000000,0x80000000,0x80000000,0xbf6c835e,0xbf710908,0xbf74fa0b,0xbf7853f8
  .long 0xbf3504f3,0xbf226799,0xbf0e39da,0xbef15aea,0x3ec3ef15,0x3f039c3d,0x3f226799,0x3f3daef9
  .long 0x3f800000,0x3f800000,0x3f800000,0x3f800000,0x3f54db31,0x3f4d9f02,0x3f45e403,0x3f3daef9
  .long 0x3ec3ef15,0x3e94a031,0x3e47c5c2,0x3dc8bd36,0xbe47c5c2,0xbeac7cd4,0xbef15aea,0xbf187fc0
  .long 0x3f800000,0x3f800000,0x3f800000,0x3f800000,0x3e47c5c2,0x3e164083,0x3dc8bd36,0x3d48fb30
  .long 0xbf6c835e,0xbf74fa0b,0xbf7b14be,0xbf7ec46d,0xbf0e39da,0xbedae880,0xbe94a031,0xbe164083
  .long 0x00000000,0x00000000,0x00000000,0x00000000,0x3f0e39da,0x3f187fc0,0x3f226799,0x3f2beb4a
  .long 0x3f6c835e,0x3f74fa0b,0x3f7b14be,0x3f7ec46d,0x3f7b14be,0x3f710908,0x3f61c598,0x3f4d9f02
  .long 0x00000000,0x00000000,0x00000000,0x00000000,0x3f7b14be,0x3f7d3aac,0x3f7ec46d,0x3f7fb10f
  .long 0x3ec3ef15,0x3e94a031,0x3e47c5c2,0x3dc8bd36,0xbf54db31,0xbf676bd8,0xbf74fa0b,0xbf7d3aac
  .long 0x3f800000,0x3f800000,0x3f800000,0x3f800000,0x3f54db31,0x3f4d9f02,0x3f45e403,0x3f3daef9
  .long 0x3ec3ef15,0x3e94a031,0x3e47c5c2,0x3dc8bd36,0xbe47c5c2,0xbeac7cd4,0xbef15aea,0xbf187fc0
  .long 0x3f800000,0x3f800000,0x3f800000,0x3f800000,0x3e47c5c2,0x3e164083,0x3dc8bd36,0x3d48fb30
  .long 0xbf6c835e,0xbf74fa0b,0xbf7b14be,0xbf7ec46d,0xbf0e39da,0xbedae880,0xbe94a031,0xbe164083
  .long 0x80000000,0x80000000,0x80000000,0x80000000,0xbf0e39da,0xbf187fc0,0xbf226799,0xbf2beb4a
  .long 0xbf6c835e,0xbf74fa0b,0xbf7b14be,0xbf7ec46d,0xbf7b14be,0xbf710908,0xbf61c598,0xbf4d9f02
  .long 0x80000000,0x80000000,0x80000000,0x80000000,0xbf7b14be,0xbf7d3aac,0xbf7ec46d,0xbf7fb10f
  .long 0xbec3ef15,0xbe94a031,0xbe47c5c2,0xbdc8bd36,0x3f54db31,0x3f676bd8,0x3f74fa0b,0x3f7d3aac
  .long 0x3f800000,0x3f7ffb11,0x3f7fec43,0x3f7fd397,0x3f800000,0x3f7f84ab,0x3f7e1324,0x3f7baccd
  .long 0x3f800000,0x3f7e70b0,0x3f79c79d,0x3f721352,0x3f800000,0x3f7cbfc9,0x3f731447,0x3f633c5a
  .long 0x3f7b14be,0x3f7a7302,0x3f79c79d,0x3f791298,0x3f0e39da,0x3f00e7e4,0x3ee63375,0x3ec9b953
  .long 0xbe47c5c2,0xbe9aa086,0xbecf7bca,0xbf00e7e4,0xbf54db31,0xbf68bf3c,0xbf76ba07,0xbf7e70b0
  .long 0x00000000,0x3c490e90,0x3cc90ab0,0x3d16c32c,0x00000000,0x3d7b2b74,0x3dfab273,0x3e3b6ecf
  .long 0x00000000,0x3de1bc2e,0x3e605c13,0x3ea68f12,0x00000000,0x3e22abb6,0x3ea09ae5,0x3eebcbbb
  .long 0x3e47c5c2,0x3e541501,0x3e605c13,0x3e6c9a7f,0x3f54db31,0x3f5d2d53,0x3f64aa59,0x3f6b4b0c
  .long 0x3f7b14be,0x3f740bdd,0x3f6a09a7,0x3f5d2d53,0x3f0e39da,0x3ed53641,0x3e888e93,0x3de1bc2e
  .long 0x3f800000,0x3f7ffb11,0x3f7fec43,0x3f7fd397,0x3f800000,0x3f7f84ab,0x3f7e1324,0x3f7baccd
  .long 0x3f800000,0x3f7e70b0,0x3f79c79d,0x3f721352,0x3f800000,0x3f7cbfc9,0x3f731447,0x3f633c5a
  .long 0x3f7b14be,0x3f7a7302,0x3f79c79d,0x3f791298,0x3f0e39da,0x3f00e7e4,0x3ee63375,0x3ec9b953
  .long 0xbe47c5c2,0xbe9aa086,0xbecf7bca,0xbf00e7e4,0xbf54db31,0xbf68bf3c,0xbf76ba07,0xbf7e70b0
  .long 0x80000000,0xbc490e90,0xbcc90ab0,0xbd16c32c,0x80000000,0xbd7b2b74,0xbdfab273,0xbe3b6ecf
  .long 0x80000000,0xbde1bc2e,0xbe605c13,0xbea68f12,0x80000000,0xbe22abb6,0xbea09ae5,0xbeebcbbb
  .long 0xbe47c5c2,0xbe541501,0xbe605c13,0xbe6c9a7f,0xbf54db31,0xbf5d2d53,0xbf64aa59,0xbf6b4b0c
  .long 0xbf7b14be,0xbf740bdd,0xbf6a09a7,0xbf5d2d53,0xbf0e39da,0xbed53641,0xbe888e93,0xbde1bc2e
  .long 0x3f7fb10f,0x3f7f84ab,0x3f7f4e6d,0x3f7f0e58,0x3f7853f8,0x3f740bdd,0x3f6ed89e,0x3f68bf3c
  .long 0x3f676bd8,0x3f59f26a,0x3f49d112,0x3f373a23,0x3f4d9f02,0x3f32c8c9,0x3f13682a,0x3ee0924f
  .long 0x3f7853f8,0x3f778bc5,0x3f76ba07,0x3f75dec6,0x3eac7cd4,0x3e8e9a22,0x3e605c13,0x3e22abb6
  .long 0xbf187fc0,0xbf2e3bde,0xbf41d870,0xbf531849,0xbf7fb10f,0xbf7a7302,0xbf6ed89e,0xbf5d2d53
  .long 0x3d48fb30,0x3d7b2b74,0x3d96a905,0x3dafb680,0x3e78cfcc,0x3e9aa086,0x3eb8442a,0x3ed53641
  .long 0x3edae880,0x3f064b82,0x3f1d7fd1,0x3f32c8c9,0x3f187fc0,0x3f373a23,0x3f514d3d,0x3f660f88
  .long 0x3e78cfcc,0x3e827dc0,0x3e888e93,0x3e8e9a22,0x3f710908,0x3f75dec6,0x3f79c79d,0x3f7cbfc9
  .long 0x3f4d9f02,0x3f3b8f3b,0x3f273656,0x3f10d3cd,0xbd48fb30,0xbe541501,0xbeb8442a,0xbf00e7e4
  .long 0x3f7fb10f,0x3f7f84ab,0x3f7f4e6d,0x3f7f0e58,0x3f7853f8,0x3f740bdd,0x3f6ed89e,0x3f68bf3c
  .long 0x3f676bd8,0x3f59f26a,0x3f49d112,0x3f373a23,0x3f4d9f02,0x3f32c8c9,0x3f13682a,0x3ee0924f
  .long 0x3f7853f8,0x3f778bc5,0x3f76ba07,0x3f75dec6,0x3eac7cd4,0x3e8e9a22,0x3e605c13,0x3e22abb6
  .long 0xbf187fc0,0xbf2e3bde,0xbf41d870,0xbf531849,0xbf7fb10f,0xbf7a7302,0xbf6ed89e,0xbf5d2d53
  .long 0xbd48fb30,0xbd7b2b74,0xbd96a905,0xbdafb680,0xbe78cfcc,0xbe9aa086,0xbeb8442a,0xbed53641
  .long 0xbedae880,0xbf064b82,0xbf1d7fd1,0xbf32c8c9,0xbf187fc0,0xbf373a23,0xbf514d3d,0xbf660f88
  .long 0xbe78cfcc,0xbe827dc0,0xbe888e93,0xbe8e9a22,0xbf710908,0xbf75dec6,0xbf79c79d,0xbf7cbfc9
  .long 0xbf4d9f02,0xbf3b8f3b,0xbf273656,0xbf10d3cd,0x3d48fb30,0x3e541501,0x3eb8442a,0x3f00e7e4
  .long 0x3f7ec46d,0x3f7e70b0,0x3f7e1324,0x3f7dabcc,0x3f61c598,0x3f59f26a,0x3f514d3d,0x3f47de65
  .long 0x3f226799,0x3f0b9a6b,0x3ee63375,0x3eb263ef,0x3e94a031,0x3e09cf86,0xbcc90ab0,0xbe3b6ecf
  .long 0x3f74fa0b,0x3f740bdd,0x3f731447,0x3f721352,0x3dc8bd36,0x3d16c32c,0xbcc90ab0,0xbdafb680
  .long 0xbf61c598,0xbf6db293,0xbf76ba07,0xbf7cbfc9,0xbf45e403,0xbf299415,0xbf08f59b,0xbec9b953
  .long 0x3dc8bd36,0x3de1bc2e,0x3dfab273,0x3e09cf86,0x3ef15aea,0x3f064b82,0x3f13682a,0x3f1ff6cb
  .long 0x3f45e403,0x3f5695e5,0x3f64aa59,0x3f6ff573,0x3f74fa0b,0x3f7dabcc,0x3f7fec43,0x3f7baccd
  .long 0x3e94a031,0x3e9aa086,0x3ea09ae5,0x3ea68f12,0x3f7ec46d,0x3f7fd397,0x3f7fec43,0x3f7f0e58
  .long 0x3ef15aea,0x3ebe1d4a,0x3e888e93,0x3e22abb6,0xbf226799,0xbf3fc767,0xbf584853,0xbf6b4b0c
  .long 0x3f7ec46d,0x3f7e70b0,0x3f7e1324,0x3f7dabcc,0x3f61c598,0x3f59f26a,0x3f514d3d,0x3f47de65
  .long 0x3f226799,0x3f0b9a6b,0x3ee63375,0x3eb263ef,0x3e94a031,0x3e09cf86,0xbcc90ab0,0xbe3b6ecf
  .long 0x3f74fa0b,0x3f740bdd,0x3f731447,0x3f721352,0x3dc8bd36,0x3d16c32c,0xbcc90ab0,0xbdafb680
  .long 0xbf61c598,0xbf6db293,0xbf76ba07,0xbf7cbfc9,0xbf45e403,0xbf299415,0xbf08f59b,0xbec9b953
  .long 0xbdc8bd36,0xbde1bc2e,0xbdfab273,0xbe09cf86,0xbef15aea,0xbf064b82,0xbf13682a,0xbf1ff6cb
  .long 0xbf45e403,0xbf5695e5,0xbf64aa59,0xbf6ff573,0xbf74fa0b,0xbf7dabcc,0xbf7fec43,0xbf7baccd
  .long 0xbe94a031,0xbe9aa086,0xbea09ae5,0xbea68f12,0xbf7ec46d,0xbf7fd397,0xbf7fec43,0xbf7f0e58
  .long 0xbef15aea,0xbebe1d4a,0xbe888e93,0xbe22abb6,0x3f226799,0x3f3fc767,0x3f584853,0x3f6b4b0c
  .long 0x3f7d3aac,0x3f7cbfc9,0x3f7c3b28,0x3f7baccd,0x3f3daef9,0x3f32c8c9,0x3f273656,0x3f1b02c6
  .long 0x3e78cfcc,0x3e09cf86,0x3cc90ab0,0xbdafb680,0xbeac7cd4,0xbef6e0cb,0xbf1d7fd1,0xbf3b8f3b
  .long 0x3f710908,0x3f6ff573,0x3f6ed89e,0x3f6db293,0xbe164083,0xbe541501,0xbe888e93,0xbea68f12
  .long 0xbf7fb10f,0xbf7f84ab,0xbf7c3b28,0xbf75dec6,0xbe78cfcc,0xbdafb680,0x3d96a905,0x3e6c9a7f
  .long 0x3e164083,0x3e22abb6,0x3e2f10a2,0x3e3b6ecf,0x3f2beb4a,0x3f373a23,0x3f41d870,0x3f4bbbf8
  .long 0x3f7853f8,0x3f7dabcc,0x3f7fec43,0x3f7f0e58,0x3f710908,0x3f604621,0x3f49d112,0x3f2e3bde
  .long 0x3eac7cd4,0x3eb263ef,0x3eb8442a,0x3ebe1d4a,0x3f7d3aac,0x3f7a7302,0x3f76ba07,0x3f721352
  .long 0x3d48fb30,0xbd7b2b74,0xbe2f10a2,0xbe8e9a22,0xbf7853f8,0xbf7f0e58,0xbf7f4e6d,0xbf791298
  .long 0x3f7d3aac,0x3f7cbfc9,0x3f7c3b28,0x3f7baccd,0x3f3daef9,0x3f32c8c9,0x3f273656,0x3f1b02c6
  .long 0x3e78cfcc,0x3e09cf86,0x3cc90ab0,0xbdafb680,0xbeac7cd4,0xbef6e0cb,0xbf1d7fd1,0xbf3b8f3b
  .long 0x3f710908,0x3f6ff573,0x3f6ed89e,0x3f6db293,0xbe164083,0xbe541501,0xbe888e93,0xbea68f12
  .long 0xbf7fb10f,0xbf7f84ab,0xbf7c3b28,0xbf75dec6,0xbe78cfcc,0xbdafb680,0x3d96a905,0x3e6c9a7f
  .long 0xbe164083,0xbe22abb6,0xbe2f10a2,0xbe3b6ecf,0xbf2beb4a,0xbf373a23,0xbf41d870,0xbf4bbbf8
  .long 0xbf7853f8,0xbf7dabcc,0xbf7fec43,0xbf7f0e58,0xbf710908,0xbf604621,0xbf49d112,0xbf2e3bde
  .long 0xbeac7cd4,0xbeb263ef,0xbeb8442a,0xbebe1d4a,0xbf7d3aac,0xbf7a7302,0xbf76ba07,0xbf721352
  .long 0xbd48fb30,0x3d7b2b74,0x3e2f10a2,0x3e8e9a22,0x3f7853f8,0x3f7f0e58,0x3f7f4e6d,0x3f791298
  .long 0x3f800000,0x3f7fec43,0x3f7fb10f,0x3f7f4e6d,0x3f800000,0x3f7f4e6d,0x3f7d3aac,0x3f79c79d
  .long 0x3f800000,0x3f7e1324,0x3f7853f8,0x3f6ed89e,0x3f800000,0x3f7c3b28,0x3f710908,0x3f5ebe05
  .long 0x3f6c835e,0x3f6a09a7,0x3f676bd8,0x3f64aa59,0x3ec3ef15,0x3ea09ae5,0x3e78cfcc,0x3e2f10a2
  .long 0xbec3ef15,0xbefc5d27,0xbf187fc0,0xbf3085bb,0xbf6c835e,0xbf79c79d,0xbf7fb10f,0xbf7e1324
  .long 0x00000000,0x3cc90ab0,0x3d48fb30,0x3d96a905,0x00000000,0x3d96a905,0x3e164083,0x3e605c13
  .long 0x00000000,0x3dfab273,0x3e78cfcc,0x3eb8442a,0x00000000,0x3e2f10a2,0x3eac7cd4,0x3efc5d27
  .long 0x3ec3ef15,0x3ecf7bca,0x3edae880,0x3ee63375,0x3f6c835e,0x3f731447,0x3f7853f8,0x3f7c3b28
  .long 0x3f6c835e,0x3f5ebe05,0x3f4d9f02,0x3f396842,0x3ec3ef15,0x3e605c13,0x3d48fb30,0xbdfab273
  .long 0x3f800000,0x3f7fec43,0x3f7fb10f,0x3f7f4e6d,0x3f800000,0x3f7f4e6d,0x3f7d3aac,0x3f79c79d
  .long 0x3f800000,0x3f7e1324,0x3f7853f8,0x3f6ed89e,0x3f800000,0x3f7c3b28,0x3f710908,0x3f5ebe05
  .long 0x3f6c835e,0x3f6a09a7,0x3f676bd8,0x3f64aa59,0x3ec3ef15,0x3ea09ae5,0x3e78cfcc,0x3e2f10a2
  .long 0xbec3ef15,0xbefc5d27,0xbf187fc0,0xbf3085bb,0xbf6c835e,0xbf79c79d,0xbf7fb10f,0xbf7e1324
  .long 0x80000000,0xbcc90ab0,0xbd48fb30,0xbd96a905,0x80000000,0xbd96a905,0xbe164083,0xbe605c13
  .long 0x80000000,0xbdfab273,0xbe78cfcc,0xbeb8442a,0x80000000,0xbe2f10a2,0xbeac7cd4,0xbefc5d27
  .long 0xbec3ef15,0xbecf7bca,0xbedae880,0xbee63375,0xbf6c835e,0xbf731447,0xbf7853f8,0xbf7c3b28
  .long 0xbf6c835e,0xbf5ebe05,0xbf4d9f02,0xbf396842,0xbec3ef15,0xbe605c13,0xbd48fb30,0x3dfab273
  .long 0x3f7ec46d,0x3f7e1324,0x3f7d3aac,0x3f7c3b28,0x3f74fa0b,0x3f6ed89e,0x3f676bd8,0x3f5ebe05
  .long 0x3f61c598,0x3f514d3d,0x3f3daef9,0x3f273656,0x3f45e403,0x3f273656,0x3f039c3d,0x3eb8442a
  .long 0x3f61c598,0x3f5ebe05,0x3f5b941a,0x3f584853,0x3dc8bd36,0x3cc90ab0,0xbd48fb30,0xbdfab273
  .long 0xbf45e403,0xbf584853,0xbf676bd8,0xbf731447,0xbf74fa0b,0xbf64aa59,0xbf4d9f02,0xbf3085bb
  .long 0x3dc8bd36,0x3dfab273,0x3e164083,0x3e2f10a2,0x3e94a031,0x3eb8442a,0x3edae880,0x3efc5d27
  .long 0x3ef15aea,0x3f13682a,0x3f2beb4a,0x3f41d870,0x3f226799,0x3f41d870,0x3f5b941a,0x3f6ed89e
  .long 0x3ef15aea,0x3efc5d27,0x3f039c3d,0x3f08f59b,0x3f7ec46d,0x3f7fec43,0x3f7fb10f,0x3f7e1324
  .long 0x3f226799,0x3f08f59b,0x3edae880,0x3ea09ae5,0xbe94a031,0xbee63375,0xbf187fc0,0xbf396842
  .long 0x3f7ec46d,0x3f7e1324,0x3f7d3aac,0x3f7c3b28,0x3f74fa0b,0x3f6ed89e,0x3f676bd8,0x3f5ebe05
  .long 0x3f61c598,0x3f514d3d,0x3f3daef9,0x3f273656,0x3f45e403,0x3f273656,0x3f039c3d,0x3eb8442a
  .long 0x3f61c598,0x3f5ebe05,0x3f5b941a,0x3f584853,0x3dc8bd36,0x3cc90ab0,0xbd48fb30,0xbdfab273
  .long 0xbf45e403,0xbf584853,0xbf676bd8,0xbf731447,0xbf74fa0b,0xbf64aa59,0xbf4d9f02,0xbf3085bb
  .long 0xbdc8bd36,0xbdfab273,0xbe164083,0xbe2f10a2,0xbe94a031,0xbeb8442a,0xbedae880,0xbefc5d27
  .long 0xbef15aea,0xbf13682a,0xbf2beb4a,0xbf41d870,0xbf226799,0xbf41d870,0xbf5b941a,0xbf6ed89e
  .long 0xbef15aea,0xbefc5d27,0xbf039c3d,0xbf08f59b,0xbf7ec46d,0xbf7fec43,0xbf7fb10f,0xbf7e1324
  .long 0xbf226799,0xbf08f59b,0xbedae880,0xbea09ae5,0x3e94a031,0x3ee63375,0x3f187fc0,0x3f396842
  .long 0x3f7b14be,0x3f79c79d,0x3f7853f8,0x3f76ba07,0x3f54db31,0x3f49d112,0x3f3daef9,0x3f3085bb
  .long 0x3f0e39da,0x3ee63375,0x3eac7cd4,0x3e605c13,0x3e47c5c2,0x3cc90ab0,0xbe164083,0xbea09ae5
  .long 0x3f54db31,0x3f514d3d,0x3f4d9f02,0x3f49d112,0xbe47c5c2,0xbe888e93,0xbeac7cd4,0xbecf7bca
  .long 0xbf7b14be,0xbf7f4e6d,0xbf7fb10f,0xbf7c3b28,0xbf0e39da,0xbecf7bca,0xbe78cfcc,0xbd96a905
  .long 0x3e47c5c2,0x3e605c13,0x3e78cfcc,0x3e888e93,0x3f0e39da,0x3f1d7fd1,0x3f2beb4a,0x3f396842
  .long 0x3f54db31,0x3f64aa59,0x3f710908,0x3f79c79d,0x3f7b14be,0x3f7fec43,0x3f7d3aac,0x3f731447
  .long 0x3f0e39da,0x3f13682a,0x3f187fc0,0x3f1d7fd1,0x3f7b14be,0x3f76ba07,0x3f710908,0x3f6a09a7
  .long 0x3e47c5c2,0x3d96a905,0xbd48fb30,0xbe2f10a2,0xbf54db31,0xbf6a09a7,0xbf7853f8,0xbf7f4e6d
  .long 0x3f7b14be,0x3f79c79d,0x3f7853f8,0x3f76ba07,0x3f54db31,0x3f49d112,0x3f3daef9,0x3f3085bb
  .long 0x3f0e39da,0x3ee63375,0x3eac7cd4,0x3e605c13,0x3e47c5c2,0x3cc90ab0,0xbe164083,0xbea09ae5
  .long 0x3f54db31,0x3f514d3d,0x3f4d9f02,0x3f49d112,0xbe47c5c2,0xbe888e93,0xbeac7cd4,0xbecf7bca
  .long 0xbf7b14be,0xbf7f4e6d,0xbf7fb10f,0xbf7c3b28,0xbf0e39da,0xbecf7bca,0xbe78cfcc,0xbd96a905
  .long 0xbe47c5c2,0xbe605c13,0xbe78cfcc,0xbe888e93,0xbf0e39da,0xbf1d7fd1,0xbf2beb4a,0xbf396842
  .long 0xbf54db31,0xbf64aa59,0xbf710908,0xbf79c79d,0xbf7b14be,0xbf7fec43,0xbf7d3aac,0xbf731447
  .long 0xbf0e39da,0xbf13682a,0xbf187fc0,0xbf1d7fd1,0xbf7b14be,0xbf76ba07,0xbf710908,0xbf6a09a7
  .long 0xbe47c5c2,0xbd96a905,0x3d48fb30,0x3e2f10a2,0x3f54db31,0x3f6a09a7,0x3f7853f8,0x3f7f4e6d
  .long 0x3f74fa0b,0x3f731447,0x3f710908,0x3f6ed89e,0x3f226799,0x3f13682a,0x3f039c3d,0x3ee63375
  .long 0x3dc8bd36,0xbcc90ab0,0xbe164083,0xbe888e93,0xbef15aea,0xbf1d7fd1,0xbf3daef9,0xbf584853
  .long 0x3f45e403,0x3f41d870,0x3f3daef9,0x3f396842,0xbef15aea,0xbf08f59b,0xbf187fc0,0xbf273656
  .long 0xbf74fa0b,0xbf6a09a7,0xbf5b941a,0xbf49d112,0x3dc8bd36,0x3e888e93,0x3edae880,0x3f13682a
  .long 0x3e94a031,0x3ea09ae5,0x3eac7cd4,0x3eb8442a,0x3f45e403,0x3f514d3d,0x3f5b941a,0x3f64aa59
  .long 0x3f7ec46d,0x3f7fec43,0x3f7d3aac,0x3f76ba07,0x3f61c598,0x3f49d112,0x3f2beb4a,0x3f08f59b
  .long 0x3f226799,0x3f273656,0x3f2beb4a,0x3f3085bb,0x3f61c598,0x3f584853,0x3f4d9f02,0x3f41d870
  .long 0xbe94a031,0xbecf7bca,0xbf039c3d,0xbf1d7fd1,0xbf7ec46d,0xbf76ba07,0xbf676bd8,0xbf514d3d
  .long 0x3f74fa0b,0x3f731447,0x3f710908,0x3f6ed89e,0x3f226799,0x3f13682a,0x3f039c3d,0x3ee63375
  .long 0x3dc8bd36,0xbcc90ab0,0xbe164083,0xbe888e93,0xbef15aea,0xbf1d7fd1,0xbf3daef9,0xbf584853
  .long 0x3f45e403,0x3f41d870,0x3f3daef9,0x3f396842,0xbef15aea,0xbf08f59b,0xbf187fc0,0xbf273656
  .long 0xbf74fa0b,0xbf6a09a7,0xbf5b941a,0xbf49d112,0x3dc8bd36,0x3e888e93,0x3edae880,0x3f13682a
  .long 0xbe94a031,0xbea09ae5,0xbeac7cd4,0xbeb8442a,0xbf45e403,0xbf514d3d,0xbf5b941a,0xbf64aa59
  .long 0xbf7ec46d,0xbf7fec43,0xbf7d3aac,0xbf76ba07,0xbf61c598,0xbf49d112,0xbf2beb4a,0xbf08f59b
  .long 0xbf226799,0xbf273656,0xbf2beb4a,0xbf3085bb,0xbf61c598,0xbf584853,0xbf4d9f02,0xbf41d870
  .long 0x3e94a031,0x3ecf7bca,0x3f039c3d,0x3f1d7fd1,0x3f7ec46d,0x3f76ba07,0x3f676bd8,0x3f514d3d
  .long 0x3f800000,0x3f7fd397,0x3f7f4e6d,0x3f7e70b0,0x3f800000,0x3f7f0e58,0x3f7c3b28,0x3f778bc5
  .long 0x3f800000,0x3f7dabcc,0x3f76ba07,0x3f6b4b0c,0x3f800000,0x3f7baccd,0x3f6ed89e,0x3f59f26a
  .long 0x3f54db31,0x3f4f7a1f,0x3f49d112,0x3f43e200,0x3e47c5c2,0x3de1bc2e,0x3cc90ab0,0xbd7b2b74
  .long 0xbf0e39da,0xbf299415,0xbf41d870,0xbf5695e5,0xbf7b14be,0xbf7ffb11,0xbf7c3b28,0xbf6ff573
  .long 0x00000000,0x3d16c32c,0x3d96a905,0x3de1bc2e,0x00000000,0x3dafb680,0x3e2f10a2,0x3e827dc0
  .long 0x00000000,0x3e09cf86,0x3e888e93,0x3ec9b953,0x00000000,0x3e3b6ecf,0x3eb8442a,0x3f064b82
  .long 0x3f0e39da,0x3f15f6d9,0x3f1d7fd1,0x3f24d225,0x3f7b14be,0x3f7e70b0,0x3f7fec43,0x3f7f84ab
  .long 0x3f54db31,0x3f3fc767,0x3f273656,0x3f0b9a6b,0x3e47c5c2,0x3c490e90,0xbe2f10a2,0xbeb263ef
  .long 0x3f800000,0x3f7fd397,0x3f7f4e6d,0x3f7e70b0,0x3f800000,0x3f7f0e58,0x3f7c3b28,0x3f778bc5
  .long 0x3f800000,0x3f7dabcc,0x3f76ba07,0x3f6b4b0c,0x3f800000,0x3f7baccd,0x3f6ed89e,0x3f59f26a
  .long 0x3f54db31,0x3f4f7a1f,0x3f49d112,0x3f43e200,0x3e47c5c2,0x3de1bc2e,0x3cc90ab0,0xbd7b2b74
  .long 0xbf0e39da,0xbf299415,0xbf41d870,0xbf5695e5,0xbf7b14be,0xbf7ffb11,0xbf7c3b28,0xbf6ff573
  .long 0x80000000,0xbd16c32c,0xbd96a905,0xbde1bc2e,0x80000000,0xbdafb680,0xbe2f10a2,0xbe827dc0
  .long 0x80000000,0xbe09cf86,0xbe888e93,0xbec9b953,0x80000000,0xbe3b6ecf,0xbeb8442a,0xbf064b82
  .long 0xbf0e39da,0xbf15f6d9,0xbf1d7fd1,0xbf24d225,0xbf7b14be,0xbf7e70b0,0xbf7fec43,0xbf7f84ab
  .long 0xbf54db31,0xbf3fc767,0xbf273656,0xbf0b9a6b,0xbe47c5c2,0xbc490e90,0x3e2f10a2,0x3eb263ef
  .long 0x3f7d3aac,0x3f7baccd,0x3f79c79d,0x3f778bc5,0x3f710908,0x3f68bf3c,0x3f5ebe05,0x3f531849
  .long 0x3f5b941a,0x3f47de65,0x3f3085bb,0x3f15f6d9,0x3f3daef9,0x3f1b02c6,0x3ee63375,0x3e8e9a22
  .long 0x3f3daef9,0x3f373a23,0x3f3085bb,0x3f299415,0xbe164083,0xbe6c9a7f,0xbea09ae5,0xbec9b953
  .long 0xbf676bd8,0xbf740bdd,0xbf7c3b28,0xbf7fd397,0xbf5b941a,0xbf3fc767,0xbf1d7fd1,0xbeebcbbb
  .long 0x3e164083,0x3e3b6ecf,0x3e605c13,0x3e827dc0,0x3eac7cd4,0x3ed53641,0x3efc5d27,0x3f10d3cd
  .long 0x3f039c3d,0x3f1ff6cb,0x3f396842,0x3f4f7a1f,0x3f2beb4a,0x3f4bbbf8,0x3f64aa59,0x3f75dec6
  .long 0x3f2beb4a,0x3f32c8c9,0x3f396842,0x3f3fc767,0x3f7d3aac,0x3f791298,0x3f731447,0x3f6b4b0c
  .long 0x3edae880,0x3e9aa086,0x3e2f10a2,0x3d16c32c,0xbf039c3d,0xbf299415,0xbf49d112,0xbf633c5a
  .long 0x3f7d3aac,0x3f7baccd,0x3f79c79d,0x3f778bc5,0x3f710908,0x3f68bf3c,0x3f5ebe05,0x3f531849
  .long 0x3f5b941a,0x3f47de65,0x3f3085bb,0x3f15f6d9,0x3f3daef9,0x3f1b02c6,0x3ee63375,0x3e8e9a22
  .long 0x3f3daef9,0x3f373a23,0x3f3085bb,0x3f299415,0xbe164083,0xbe6c9a7f,0xbea09ae5,0xbec9b953
  .long 0xbf676bd8,0xbf740bdd,0xbf7c3b28,0xbf7fd397,0xbf5b941a,0xbf3fc767,0xbf1d7fd1,0xbeebcbbb
  .long 0xbe164083,0xbe3b6ecf,0xbe605c13,0xbe827dc0,0xbeac7cd4,0xbed53641,0xbefc5d27,0xbf10d3cd
  .long 0xbf039c3d,0xbf1ff6cb,0xbf396842,0xbf4f7a1f,0xbf2beb4a,0xbf4bbbf8,0xbf64aa59,0xbf75dec6
  .long 0xbf2beb4a,0xbf32c8c9,0xbf396842,0xbf3fc767,0xbf7d3aac,0xbf791298,0xbf731447,0xbf6b4b0c
  .long 0xbedae880,0xbe9aa086,0xbe2f10a2,0xbd16c32c,0x3f039c3d,0x3f299415,0x3f49d112,0x3f633c5a
  .long 0x3f74fa0b,0x3f721352,0x3f6ed89e,0x3f6b4b0c,0x3f45e403,0x3f373a23,0x3f273656,0x3f15f6d9
  .long 0x3ef15aea,0x3eb263ef,0x3e605c13,0x3dafb680,0x3dc8bd36,0xbdafb680,0xbe888e93,0xbee0924f
  .long 0x3f226799,0x3f1b02c6,0x3f13682a,0x3f0b9a6b,0xbef15aea,0xbf0b9a6b,0xbf1d7fd1,0xbf2e3bde
  .long 0xbf7ec46d,0xbf791298,0xbf6ed89e,0xbf604621,0xbe94a031,0xbde1bc2e,0x3d96a905,0x3e827dc0
  .long 0x3e94a031,0x3ea68f12,0x3eb8442a,0x3ec9b953,0x3f226799,0x3f32c8c9,0x3f41d870,0x3f4f7a1f
  .long 0x3f61c598,0x3f6ff573,0x3f79c79d,0x3f7f0e58,0x3f7ec46d,0x3f7f0e58,0x3f76ba07,0x3f660f88
  .long 0x3f45e403,0x3f4bbbf8,0x3f514d3d,0x3f5695e5,0x3f61c598,0x3f5695e5,0x3f49d112,0x3f3b8f3b
  .long 0xbdc8bd36,0xbe6c9a7f,0xbeb8442a,0xbef6e0cb,0xbf74fa0b,0xbf7e70b0,0xbf7f4e6d,0xbf778bc5
  .long 0x3f74fa0b,0x3f721352,0x3f6ed89e,0x3f6b4b0c,0x3f45e403,0x3f373a23,0x3f273656,0x3f15f6d9
  .long 0x3ef15aea,0x3eb263ef,0x3e605c13,0x3dafb680,0x3dc8bd36,0xbdafb680,0xbe888e93,0xbee0924f
  .long 0x3f226799,0x3f1b02c6,0x3f13682a,0x3f0b9a6b,0xbef15aea,0xbf0b9a6b,0xbf1d7fd1,0xbf2e3bde
  .long 0xbf7ec46d,0xbf791298,0xbf6ed89e,0xbf604621,0xbe94a031,0xbde1bc2e,0x3d96a905,0x3e827dc0
  .long 0xbe94a031,0xbea68f12,0xbeb8442a,0xbec9b953,0xbf226799,0xbf32c8c9,0xbf41d870,0xbf4f7a1f
  .long 0xbf61c598,0xbf6ff573,0xbf79c79d,0xbf7f0e58,0xbf7ec46d,0xbf7f0e58,0xbf76ba07,0xbf660f88
  .long 0xbf45e403,0xbf4bbbf8,0xbf514d3d,0xbf5695e5,0xbf61c598,0xbf5695e5,0xbf49d112,0xbf3b8f3b
  .long 0x3dc8bd36,0x3e6c9a7f,0x3eb8442a,0x3ef6e0cb,0x3f74fa0b,0x3f7e70b0,0x3f7f4e6d,0x3f778bc5
  .long 0x3f676bd8,0x3f633c5a,0x3f5ebe05,0x3f59f26a,0x3f039c3d,0x3ee0924f,0x3eb8442a,0x3e8e9a22
  .long 0xbd48fb30,0xbe3b6ecf,0xbea09ae5,0xbee0924f,0xbf187fc0,0xbf3b8f3b,0xbf584853,0xbf6db293
  .long 0x3f039c3d,0x3ef6e0cb,0x3ee63375,0x3ed53641,0xbf3daef9,0xbf4bbbf8,0xbf584853,0xbf633c5a
  .long 0xbf4d9f02,0xbf373a23,0xbf1d7fd1,0xbf00e7e4,0x3edae880,0x3f15f6d9,0x3f396842,0x3f5695e5
  .long 0x3edae880,0x3eebcbbb,0x3efc5d27,0x3f064b82,0x3f5b941a,0x3f660f88,0x3f6ed89e,0x3f75dec6
  .long 0x3f7fb10f,0x3f7baccd,0x3f731447,0x3f660f88,0x3f4d9f02,0x3f2e3bde,0x3f08f59b,0x3ebe1d4a
  .long 0x3f5b941a,0x3f604621,0x3f64aa59,0x3f68bf3c,0x3f2beb4a,0x3f1b02c6,0x3f08f59b,0x3eebcbbb
  .long 0xbf187fc0,0xbf32c8c9,0xbf49d112,0xbf5d2d53,0xbf676bd8,0xbf4f7a1f,0xbf3085bb,0xbf0b9a6b
  .long 0x3f676bd8,0x3f633c5a,0x3f5ebe05,0x3f59f26a,0x3f039c3d,0x3ee0924f,0x3eb8442a,0x3e8e9a22
  .long 0xbd48fb30,0xbe3b6ecf,0xbea09ae5,0xbee0924f,0xbf187fc0,0xbf3b8f3b,0xbf584853,0xbf6db293
  .long 0x3f039c3d,0x3ef6e0cb,0x3ee63375,0x3ed53641,0xbf3daef9,0xbf4bbbf8,0xbf584853,0xbf633c5a
  .long 0xbf4d9f02,0xbf373a23,0xbf1d7fd1,0xbf00e7e4,0x3edae880,0x3f15f6d9,0x3f396842,0x3f5695e5
  .long 0xbedae880,0xbeebcbbb,0xbefc5d27,0xbf064b82,0xbf5b941a,0xbf660f88,0xbf6ed89e,0xbf75dec6
  .long 0xbf7fb10f,0xbf7baccd,0xbf731447,0xbf660f88,0xbf4d9f02,0xbf2e3bde,0xbf08f59b,0xbebe1d4a
  .long 0xbf5b941a,0xbf604621,0xbf64aa59,0xbf68bf3c,0xbf2beb4a,0xbf1b02c6,0xbf08f59b,0xbeebcbbb
  .long 0x3f187fc0,0x3f32c8c9,0x3f49d112,0x3f5d2d53,0x3f676bd8,0x3f4f7a1f,0x3f3085bb,0x3f0b9a6b
  .long 0x3f803f80,0x3f803f80,0x00000000,0x00000000,0x248d3f80,0xa554bf80,0x3f800000,0xbf80250d
  .long 0xbf803f80,0xbf803f80,0x250d0000,0x250d0000,0xa5543f80,0x248dbf80,0xbf800000,0x3f80250d
  .long 0x3f803f80,0x3f803f80,0x00000000,0x00000000,0x248d3f80,0xa554bf80,0x3f800000,0xbf80250d
  .long 0xbf803f80,0xbf803f80,0x250d0000,0x250d0000,0xa5543f80,0x248dbf80,0xbf800000,0x3f80250d
  .long 0x3f803f80,0x3f803f80,0x00000000,0x00000000,0x248d3f80,0xa554bf80,0x3f800000,0xbf80250d
  .long 0xbf803f80,0xbf803f80,0x250d0000,0x250d0000,0xa5543f80,0x248dbf80,0xbf800000,0x3f80250d
  .long 0x3f803f80,0x3f803f80,0x00000000,0x00000000,0x248d3f80,0xa554bf80,0x3f800000,0xbf80250d
  .long 0xbf803f80,0xbf803f80,0x250d0000,0x250d0000,0xa5543f80,0x248dbf80,0xbf800000,0x3f80250d
  .long 0x3f803f80,0x3f803f80,0x00000000,0x00000000,0xbec43f6d,0x3ec4bf6d,0x3f6d3ec4,0xbf6dbec4
  .long 0xbf353f35,0xbf353f35,0xbf353f35,0xbf353f35,0x3f6d3ec4,0xbf6dbec4,0xbec43f6d,0x3ec4bf6d
  .long 0x248d248d,0x248d248d,0x3f803f80,0x3f803f80,0xbf6dbec4,0x3f6d3ec4,0xbec43f6d,0x3ec4bf6d
  .long 0x3f35bf35,0x3f35bf35,0xbf353f35,0xbf353f35,0x3ec4bf6d,0xbec43f6d,0x3f6d3ec4,0xbf6dbec4
  .long 0xbf80bf80,0xbf80bf80,0x250d250d,0x250d250d,0x3ec4bf6d,0xbec43f6d,0xbf6dbec4,0x3f6d3ec4
  .long 0x3f35bf35,0x3f35bf35,0x3f35bf35,0x3f35bf35,0xbf6dbec4,0x3f6d3ec4,0x3ec4bf6d,0xbec43f6d
  .long 0xa554a554,0xa554a554,0xbf80bf80,0xbf80bf80,0x3f6d3ec4,0xbf6dbec4,0x3ec4bf6d,0xbec43f6d
  .long 0xbf353f35,0xbf353f35,0x3f35bf35,0x3f35bf35,0xbec43f6d,0x3ec4bf6d,0xbf6dbec4,0x3f6d3ec4
  .long 0x3f803f80,0x3f803f80,0x00000000,0x00000000,0xbf353f35,0x3f35bf35,0x3f353f35,0xbf35bf35
  .long 0xa554248d,0xa554248d,0xbf803f80,0xbf803f80,0x3f35bf35,0xbf353f35,0x3f353f35,0xbf35bf35
  .long 0xbf80bf80,0xbf80bf80,0x250d250d,0x250d250d,0x3f35bf35,0xbf353f35,0xbf35bf35,0x3f353f35
  .long 0x248da554,0x248da554,0x3f80bf80,0x3f80bf80,0xbf353f35,0x3f35bf35,0xbf35bf35,0x3f353f35
  .long 0x3f803f80,0x3f803f80,0x00000000,0x00000000,0xbf353f35,0x3f35bf35,0x3f353f35,0xbf35bf35
  .long 0xa554248d,0xa554248d,0xbf803f80,0xbf803f80,0x3f35bf35,0xbf353f35,0x3f353f35,0xbf35bf35
  .long 0xbf80bf80,0xbf80bf80,0x250d250d,0x250d250d,0x3f35bf35,0xbf353f35,0xbf35bf35,0x3f353f35
  .long 0x248da554,0x248da554,0x3f80bf80,0x3f80bf80,0xbf353f35,0x3f35bf35,0xbf35bf35,0x3f353f35
  .long 0x3f803f80,0x3f803f80,0x00000000,0x00000000,0xbf6d3ec4,0x3f6dbec4,0x3ec43f6d,0xbec4bf6d
  .long 0x3f35bf35,0x3f35bf35,0xbf353f35,0xbf353f35,0xbec4bf6d,0x3ec43f6d,0x3f6dbec4,0xbf6d3ec4
  .long 0xa554a554,0xa554a554,0xbf80bf80,0xbf80bf80,0x3ec43f6d,0xbec4bf6d,0x3f6dbec4,0xbf6d3ec4
  .long 0xbf353f35,0xbf353f35,0xbf353f35,0xbf353f35,0x3f6dbec4,0xbf6d3ec4,0x3ec43f6d,0xbec4bf6d
  .long 0xbf80bf80,0xbf80bf80,0x250d250d,0x250d250d,0x3f6dbec4,0xbf6d3ec4,0xbec4bf6d,0x3ec43f6d
  .long 0xbf353f35,0xbf353f35,0x3f35bf35,0x3f35bf35,0x3ec43f6d,0xbec4bf6d,0xbf6d3ec4,0x3f6dbec4
  .long 0x248d248d,0x248d248d,0x3f803f80,0x3f803f80,0xbec4bf6d,0x3ec43f6d,0xbf6d3ec4,0x3f6dbec4
  .long 0x3f35bf35,0x3f35bf35,0x3f35bf35,0x3f35bf35,0xbf6d3ec4,0x3f6dbec4,0xbec4bf6d,0x3ec43f6d
  .long 0x3f803f80,0x3f803f80,0x00000000,0x00000000,0x248d3f80,0xa554bf80,0x3f800000,0xbf80250d
  .long 0xbf803f80,0xbf803f80,0x250d0000,0x250d0000,0xa5543f80,0x248dbf80,0xbf800000,0x3f80250d
  .long 0x3f803f80,0x3f803f80,0x00000000,0x00000000,0x248d3f80,0xa554bf80,0x3f800000,0xbf80250d
  .long 0xbf803f80,0xbf803f80,0x250d0000,0x250d0000,0xa5543f80,0x248dbf80,0xbf800000,0x3f80250d
  .long 0x3f803f80,0x3f803f80,0x00000000,0x00000000,0x248d3f80,0xa554bf80,0x3f800000,0xbf80250d
  .long 0xbf803f80,0xbf803f80,0x250d0000,0x250d0000,0xa5543f80,0x248dbf80,0xbf800000,0x3f80250d
  .long 0x3f803f80,0x3f803f80,0x00000000,0x00000000,0x248d3f80,0xa554bf80,0x3f800000,0xbf80250d
  .long 0xbf803f80,0xbf803f80,0x250d0000,0x250d0000,0xa5543f80,0x248dbf80,0xbf800000,0x3f80250d
  .long 0x3f803f80,0x3f803f80,0x00000000,0x00000000,0xbec43f6d,0x3ec4bf6d,0x3f6d3ec4,0xbf6dbec4
  .long 0xbf353f35,0xbf353f35,0xbf353f35,0xbf353f35,0x3f6d3ec4,0xbf6dbec4,0xbec43f6d,0x3ec4bf6d
  .long 0x248d248d,0x248d248d,0x3f803f80,0x3f803f80,0xbf6dbec4,0x3f6d3ec4,0xbec43f6d,0x3ec4bf6d
  .long 0x3f35bf35,0x3f35bf35,0xbf353f35,0xbf353f35,0x3ec4bf6d,0xbec43f6d,0x3f6d3ec4,0xbf6dbec4
  .long 0xbf80bf80,0xbf80bf80,0x250d250d,0x250d250d,0x3ec4bf6d,0xbec43f6d,0xbf6dbec4,0x3f6d3ec4
  .long 0x3f35bf35,0x3f35bf35,0x3f35bf35,0x3f35bf35,0xbf6dbec4,0x3f6d3ec4,0x3ec4bf6d,0xbec43f6d
  .long 0xa554a554,0xa554a554,0xbf80bf80,0xbf80bf80,0x3f6d3ec4,0xbf6dbec4,0x3ec4bf6d,0xbec43f6d
  .long 0xbf353f35,0xbf353f35,0x3f35bf35,0x3f35bf35,0xbec43f6d,0x3ec4bf6d,0xbf6dbec4,0x3f6d3ec4
  .long 0x3f803f80,0x3f803f80,0x00000000,0x00000000,0xbf353f35,0x3f35bf35,0x3f353f35,0xbf35bf35
  .long 0xa554248d,0xa554248d,0xbf803f80,0xbf803f80,0x3f35bf35,0xbf353f35,0x3f353f35,0xbf35bf35
  .long 0xbf80bf80,0xbf80bf80,0x250d250d,0x250d250d,0x3f35bf35,0xbf353f35,0xbf35bf35,0x3f353f35
  .long 0x248da554,0x248da554,0x3f80bf80,0x3f80bf80,0xbf353f35,0x3f35bf35,0xbf35bf35,0x3f353f35
  .long 0x3f803f80,0x3f803f80,0x00000000,0x00000000,0xbf353f35,0x3f35bf35,0x3f353f35,0xbf35bf35
  .long 0xa554248d,0xa554248d,0xbf803f80,0xbf803f80,0x3f35bf35,0xbf353f35,0x3f353f35,0xbf35bf35
  .long 0xbf80bf80,0xbf80bf80,0x250d250d,0x250d250d,0x3f35bf35,0xbf353f35,0xbf35bf35,0x3f353f35
  .long 0x248da554,0x248da554,0x3f80bf80,0x3f80bf80,0xbf353f35,0x3f35bf35,0xbf35bf35,0x3f353f35
  .long 0x3f803f80,0x3f803f80,0x00000000,0x00000000,0xbf6d3ec4,0x3f6dbec4,0x3ec43f6d,0xbec4bf6d
  .long 0x3f35bf35,0x3f35bf35,0xbf353f35,0xbf353f35,0xbec4bf6d,0x3ec43f6d,0x3f6dbec4,0xbf6d3ec4
  .long 0xa554a554,0xa554a554,0xbf80bf80,0xbf80bf80,0x3ec43f6d,0xbec4bf6d,0x3f6dbec4,0xbf6d3ec4
  .long 0xbf353f35,0xbf353f35,0xbf353f35,0xbf353f35,0x3f6dbec4,0xbf6d3ec4,0x3ec43f6d,0xbec4bf6d
  .long 0xbf80bf80,0xbf80bf80,0x250d250d,0x250d250d,0x3f6dbec4,0xbf6d3ec4,0xbec4bf6d,0x3ec43f6d
  .long 0xbf353f35,0xbf353f35,0x3f35bf35,0x3f35bf35,0x3ec43f6d,0xbec4bf6d,0xbf6d3ec4,0x3f6dbec4
  .long 0x248d248d,0x248d248d,0x3f803f80,0x3f803f80,0xbec4bf6d,0x3ec43f6d,0xbf6d3ec4,0x3f6dbec4
  .long 0x3f35bf35,0x3f35bf35,0x3f35bf35,0x3f35bf35,0xbf6d3ec4,0x3f6dbec4,0xbec4bf6d,0x3ec43f6d
  .long 0xa5543f80,0x248dbf80,0xbf800000,0x3f80250d,0xbf803f80,0xbf803f80,0x250d0000,0x250d0000
  .long 0x248d3f80,0xa554bf80,0x3f800000,0xbf80250d,0x3f803f80,0x3f803f80,0x00000000,0x00000000
  .long 0xa5543f80,0x248dbf80,0xbf800000,0x3f80250d,0xbf803f80,0xbf803f80,0x250d0000,0x250d0000
  .long 0x248d3f80,0xa554bf80,0x3f800000,0xbf80250d,0x3f803f80,0x3f803f80,0x00000000,0x00000000
  .long 0xa5543f80,0x248dbf80,0xbf800000,0x3f80250d,0xbf803f80,0xbf803f80,0x250d0000,0x250d0000
  .long 0x248d3f80,0xa554bf80,0x3f800000,0xbf80250d,0x3f803f80,0x3f803f80,0x00000000,0x00000000
  .long 0xa5543f80,0x248dbf80,0xbf800000,0x3f80250d,0xbf803f80,0xbf803f80,0x250d0000,0x250d0000
  .long 0x248d3f80,0xa554bf80,0x3f800000,0xbf80250d,0x3f803f80,0x3f803f80,0x00000000,0x00000000
  .long 0xbec43f6d,0x3ec4bf6d,0xbf6dbec4,0x3f6d3ec4,0xbf353f35,0xbf353f35,0x3f35bf35,0x3f35bf35
  .long 0x3f6d3ec4,0xbf6dbec4,0x3ec4bf6d,0xbec43f6d,0xa554a554,0xa554a554,0xbf80bf80,0xbf80bf80
  .long 0xbf6dbec4,0x3f6d3ec4,0x3ec4bf6d,0xbec43f6d,0x3f35bf35,0x3f35bf35,0x3f35bf35,0x3f35bf35
  .long 0x3ec4bf6d,0xbec43f6d,0xbf6dbec4,0x3f6d3ec4,0xbf80bf80,0xbf80bf80,0x250d250d,0x250d250d
  .long 0x3ec4bf6d,0xbec43f6d,0x3f6d3ec4,0xbf6dbec4,0x3f35bf35,0x3f35bf35,0xbf353f35,0xbf353f35
  .long 0xbf6dbec4,0x3f6d3ec4,0xbec43f6d,0x3ec4bf6d,0x248d248d,0x248d248d,0x3f803f80,0x3f803f80
  .long 0x3f6d3ec4,0xbf6dbec4,0xbec43f6d,0x3ec4bf6d,0xbf353f35,0xbf353f35,0xbf353f35,0xbf353f35
  .long 0xbec43f6d,0x3ec4bf6d,0x3f6d3ec4,0xbf6dbec4,0x3f803f80,0x3f803f80,0x00000000,0x00000000
  .long 0xbf353f35,0x3f35bf35,0xbf35bf35,0x3f353f35,0x248da554,0x248da554,0x3f80bf80,0x3f80bf80
  .long 0x3f35bf35,0xbf353f35,0xbf35bf35,0x3f353f35,0xbf80bf80,0xbf80bf80,0x250d250d,0x250d250d
  .long 0x3f35bf35,0xbf353f35,0x3f353f35,0xbf35bf35,0xa554248d,0xa554248d,0xbf803f80,0xbf803f80
  .long 0xbf353f35,0x3f35bf35,0x3f353f35,0xbf35bf35,0x3f803f80,0x3f803f80,0x00000000,0x00000000
  .long 0xbf353f35,0x3f35bf35,0xbf35bf35,0x3f353f35,0x248da554,0x248da554,0x3f80bf80,0x3f80bf80
  .long 0x3f35bf35,0xbf353f35,0xbf35bf35,0x3f353f35,0xbf80bf80,0xbf80bf80,0x250d250d,0x250d250d
  .long 0x3f35bf35,0xbf353f35,0x3f353f35,0xbf35bf35,0xa554248d,0xa554248d,0xbf803f80,0xbf803f80
  .long 0xbf353f35,0x3f35bf35,0x3f353f35,0xbf35bf35,0x3f803f80,0x3f803f80,0x00000000,0x00000000
  .long 0xbf6d3ec4,0x3f6dbec4,0xbec4bf6d,0x3ec43f6d,0x3f35bf35,0x3f35bf35,0x3f35bf35,0x3f35bf35
  .long 0xbec4bf6d,0x3ec43f6d,0xbf6d3ec4,0x3f6dbec4,0x248d248d,0x248d248d,0x3f803f80,0x3f803f80
  .long 0x3ec43f6d,0xbec4bf6d,0xbf6d3ec4,0x3f6dbec4,0xbf353f35,0xbf353f35,0x3f35bf35,0x3f35bf35
  .long 0x3f6dbec4,0xbf6d3ec4,0xbec4bf6d,0x3ec43f6d,0xbf80bf80,0xbf80bf80,0x250d250d,0x250d250d
  .long 0x3f6dbec4,0xbf6d3ec4,0x3ec43f6d,0xbec4bf6d,0xbf353f35,0xbf353f35,0xbf353f35,0xbf353f35
  .long 0x3ec43f6d,0xbec4bf6d,0x3f6dbec4,0xbf6d3ec4,0xa554a554,0xa554a554,0xbf80bf80,0xbf80bf80
  .long 0xbec4bf6d,0x3ec43f6d,0x3f6dbec4,0xbf6d3ec4,0x3f35bf35,0x3f35bf35,0xbf353f35,0xbf353f35
  .long 0xbf6d3ec4,0x3f6dbec4,0x3ec43f6d,0xbec4bf6d,0x3f803f80,0x3f803f80,0x00000000,0x00000000
  .long 0x3f803f80,0x3f803f80,0x00000000,0x00000000,0xa5543f80,0x248dbf80,0xbf800000,0x3f80250d
  .long 0xbf803f80,0xbf803f80,0x250d0000,0x250d0000,0x248d3f80,0xa554bf80,0x3f800000,0xbf80250d
  .long 0x3f803f80,0x3f803f80,0x00000000,0x00000000,0xa5543f80,0x248dbf80,0xbf800000,0x3f80250d
  .long 0xbf803f80,0xbf803f80,0x250d0000,0x250d0000,0x248d3f80,0xa554bf80,0x3f800000,0xbf80250d
  .long 0x3f803f80,0x3f803f80,0x00000000,0x00000000,0xa5543f80,0x248dbf80,0xbf800000,0x3f80250d
  .long 0xbf803f80,0xbf803f80,0x250d0000,0x250d0000,0x248d3f80,0xa554bf80,0x3f800000,0xbf80250d
  .long 0x3f803f80,0x3f803f80,0x00000000,0x00000000,0xa5543f80,0x248dbf80,0xbf800000,0x3f80250d
  .long 0xbf803f80,0xbf803f80,0x250d0000,0x250d0000,0x248d3f80,0xa554bf80,0x3f800000,0xbf80250d
  .long 0x3f803f80,0x3f803f80,0x00000000,0x00000000,0xbec43f6d,0x3ec4bf6d,0xbf6dbec4,0x3f6d3ec4
  .long 0xbf353f35,0xbf353f35,0x3f35bf35,0x3f35bf35,0x3f6d3ec4,0xbf6dbec4,0x3ec4bf6d,0xbec43f6d
  .long 0xa554a554,0xa554a554,0xbf80bf80,0xbf80bf80,0xbf6dbec4,0x3f6d3ec4,0x3ec4bf6d,0xbec43f6d
  .long 0x3f35bf35,0x3f35bf35,0x3f35bf35,0x3f35bf35,0x3ec4bf6d,0xbec43f6d,0xbf6dbec4,0x3f6d3ec4
  .long 0xbf80bf80,0xbf80bf80,0x250d250d,0x250d250d,0x3ec4bf6d,0xbec43f6d,0x3f6d3ec4,0xbf6dbec4
  .long 0x3f35bf35,0x3f35bf35,0xbf353f35,0xbf353f35,0xbf6dbec4,0x3f6d3ec4,0xbec43f6d,0x3ec4bf6d
  .long 0x248d248d,0x248d248d,0x3f803f80,0x3f803f80,0x3f6d3ec4,0xbf6dbec4,0xbec43f6d,0x3ec4bf6d
  .long 0xbf353f35,0xbf353f35,0xbf353f35,0xbf353f35,0xbec43f6d,0x3ec4bf6d,0x3f6d3ec4,0xbf6dbec4
  .long 0x3f803f80,0x3f803f80,0x00000000,0x00000000,0xbf353f35,0x3f35bf35,0xbf35bf35,0x3f353f35
  .long 0x248da554,0x248da554,0x3f80bf80,0x3f80bf80,0x3f35bf35,0xbf353f35,0xbf35bf35,0x3f353f35
  .long 0xbf80bf80,0xbf80bf80,0x250d250d,0x250d250d,0x3f35bf35,0xbf353f35,0x3f353f35,0xbf35bf35
  .long 0xa554248d,0xa554248d,0xbf803f80,0xbf803f80,0xbf353f35,0x3f35bf35,0x3f353f35,0xbf35bf35
  .long 0x3f803f80,0x3f803f80,0x00000000,0x00000000,0xbf353f35,0x3f35bf35,0xbf35bf35,0x3f353f35
  .long 0x248da554,0x248da554,0x3f80bf80,0x3f80bf80,0x3f35bf35,0xbf353f35,0xbf35bf35,0x3f353f35
  .long 0xbf80bf80,0xbf80bf80,0x250d250d,0x250d250d,0x3f35bf35,0xbf353f35,0x3f353f35,0xbf35bf35
  .long 0xa554248d,0xa554248d,0xbf803f80,0xbf803f80,0xbf353f35,0x3f35bf35,0x3f353f35,0xbf35bf35
  .long 0x3f803f80,0x3f803f80,0x00000000,0x00000000,0xbf6d3ec4,0x3f6dbec4,0xbec4bf6d,0x3ec43f6d
  .long 0x3f35bf35,0x3f35bf35,0x3f35bf35,0x3f35bf35,0xbec4bf6d,0x3ec43f6d,0xbf6d3ec4,0x3f6dbec4
  .long 0x248d248d,0x248d248d,0x3f803f80,0x3f803f80,0x3ec43f6d,0xbec4bf6d,0xbf6d3ec4,0x3f6dbec4
  .long 0xbf353f35,0xbf353f35,0x3f35bf35,0x3f35bf35,0x3f6dbec4,0xbf6d3ec4,0xbec4bf6d,0x3ec43f6d
  .long 0xbf80bf80,0xbf80bf80,0x250d250d,0x250d250d,0x3f6dbec4,0xbf6d3ec4,0x3ec43f6d,0xbec4bf6d
  .long 0xbf353f35,0xbf353f35,0xbf353f35,0xbf353f35,0x3ec43f6d,0xbec4bf6d,0x3f6dbec4,0xbf6d3ec4
  .long 0xa554a554,0xa554a554,0xbf80bf80,0xbf80bf80,0xbec4bf6d,0x3ec43f6d,0x3f6dbec4,0xbf6d3ec4
  .long 0x3f35bf35,0x3f35bf35,0xbf353f35,0xbf353f35,0xbf6d3ec4,0x3f6dbec4,0x3ec43f6d,0xbec4bf6d
  .long 0x80008000,0x80008000,0x3f803f80,0x3f803f80,0xbf808000,0x3f80a50d,0x248d3f80,0xa554bf80
  .long 0xa50d8000,0xa50d8000,0xbf803f80,0xbf803f80,0x3f808000,0xbf80a50d,0xa5543f80,0x248dbf80
  .long 0x80008000,0x80008000,0x3f803f80,0x3f803f80,0xbf808000,0x3f80a50d,0x248d3f80,0xa554bf80
  .long 0xa50d8000,0xa50d8000,0xbf803f80,0xbf803f80,0x3f808000,0xbf80a50d,0xa5543f80,0x248dbf80
  .long 0x80008000,0x80008000,0x3f803f80,0x3f803f80,0xbf808000,0x3f80a50d,0x248d3f80,0xa554bf80
  .long 0xa50d8000,0xa50d8000,0xbf803f80,0xbf803f80,0x3f808000,0xbf80a50d,0xa5543f80,0x248dbf80
  .long 0x80008000,0x80008000,0x3f803f80,0x3f803f80,0xbf808000,0x3f80a50d,0x248d3f80,0xa554bf80
  .long 0xa50d8000,0xa50d8000,0xbf803f80,0xbf803f80,0x3f808000,0xbf80a50d,0xa5543f80,0x248dbf80
  .long 0x80008000,0x80008000,0x3f803f80,0x3f803f80,0xbf6dbec4,0x3f6d3ec4,0xbec43f6d,0x3ec4bf6d
  .long 0x3f35bf35,0x3f35bf35,0xbf353f35,0xbf353f35,0x3ec4bf6d,0xbec43f6d,0x3f6d3ec4,0xbf6dbec4
  .long 0xbf80bf80,0xbf80bf80,0x248d248d,0x248d248d,0x3ec4bf6d,0xbec43f6d,0xbf6dbec4,0x3f6d3ec4
  .long 0x3f35bf35,0x3f35bf35,0x3f35bf35,0x3f35bf35,0xbf6dbec4,0x3f6d3ec4,0x3ec4bf6d,0xbec43f6d
  .long 0xa50da50d,0xa50da50d,0xbf80bf80,0xbf80bf80,0x3f6d3ec4,0xbf6dbec4,0x3ec4bf6d,0xbec43f6d
  .long 0xbf353f35,0xbf353f35,0x3f35bf35,0x3f35bf35,0xbec43f6d,0x3ec4bf6d,0xbf6dbec4,0x3f6d3ec4
  .long 0x3f803f80,0x3f803f80,0xa554a554,0xa554a554,0xbec43f6d,0x3ec4bf6d,0x3f6d3ec4,0xbf6dbec4
  .long 0xbf353f35,0xbf353f35,0xbf353f35,0xbf353f35,0x3f6d3ec4,0xbf6dbec4,0xbec43f6d,0x3ec4bf6d
  .long 0x80008000,0x80008000,0x3f803f80,0x3f803f80,0xbf35bf35,0x3f353f35,0xbf353f35,0x3f35bf35
  .long 0x3f80bf80,0x3f80bf80,0xa554248d,0xa554248d,0xbf35bf35,0x3f353f35,0x3f35bf35,0xbf353f35
  .long 0xa50da50d,0xa50da50d,0xbf80bf80,0xbf80bf80,0x3f353f35,0xbf35bf35,0x3f35bf35,0xbf353f35
  .long 0xbf803f80,0xbf803f80,0x248da554,0x248da554,0x3f353f35,0xbf35bf35,0xbf353f35,0x3f35bf35
  .long 0x80008000,0x80008000,0x3f803f80,0x3f803f80,0xbf35bf35,0x3f353f35,0xbf353f35,0x3f35bf35
  .long 0x3f80bf80,0x3f80bf80,0xa554248d,0xa554248d,0xbf35bf35,0x3f353f35,0x3f35bf35,0xbf353f35
  .long 0xa50da50d,0xa50da50d,0xbf80bf80,0xbf80bf80,0x3f353f35,0xbf35bf35,0x3f35bf35,0xbf353f35
  .long 0xbf803f80,0xbf803f80,0x248da554,0x248da554,0x3f353f35,0xbf35bf35,0xbf353f35,0x3f35bf35
  .long 0x80008000,0x80008000,0x3f803f80,0x3f803f80,0xbec4bf6d,0x3ec43f6d,0xbf6d3ec4,0x3f6dbec4
  .long 0x3f35bf35,0x3f35bf35,0x3f35bf35,0x3f35bf35,0xbf6d3ec4,0x3f6dbec4,0xbec4bf6d,0x3ec43f6d
  .long 0x3f803f80,0x3f803f80,0xa554a554,0xa554a554,0xbf6d3ec4,0x3f6dbec4,0x3ec43f6d,0xbec4bf6d
  .long 0x3f35bf35,0x3f35bf35,0xbf353f35,0xbf353f35,0xbec4bf6d,0x3ec43f6d,0x3f6dbec4,0xbf6d3ec4
  .long 0xa50da50d,0xa50da50d,0xbf80bf80,0xbf80bf80,0x3ec43f6d,0xbec4bf6d,0x3f6dbec4,0xbf6d3ec4
  .long 0xbf353f35,0xbf353f35,0xbf353f35,0xbf353f35,0x3f6dbec4,0xbf6d3ec4,0x3ec43f6d,0xbec4bf6d
  .long 0xbf80bf80,0xbf80bf80,0x248d248d,0x248d248d,0x3f6dbec4,0xbf6d3ec4,0xbec4bf6d,0x3ec43f6d
  .long 0xbf353f35,0xbf353f35,0x3f35bf35,0x3f35bf35,0x3ec43f6d,0xbec4bf6d,0xbf6d3ec4,0x3f6dbec4
  .long 0x3f808000,0xbf80a50d,0xa5543f80,0x248dbf80,0xa50d8000,0xa50d8000,0xbf803f80,0xbf803f80
  .long 0xbf808000,0x3f80a50d,0x248d3f80,0xa554bf80,0x80008000,0x80008000,0x3f803f80,0x3f803f80
  .long 0x3f808000,0xbf80a50d,0xa5543f80,0x248dbf80,0xa50d8000,0xa50d8000,0xbf803f80,0xbf803f80
  .long 0xbf808000,0x3f80a50d,0x248d3f80,0xa554bf80,0x80008000,0x80008000,0x3f803f80,0x3f803f80
  .long 0x3f808000,0xbf80a50d,0xa5543f80,0x248dbf80,0xa50d8000,0xa50d8000,0xbf803f80,0xbf803f80
  .long 0xbf808000,0x3f80a50d,0x248d3f80,0xa554bf80,0x80008000,0x80008000,0x3f803f80,0x3f803f80
  .long 0x3f808000,0xbf80a50d,0xa5543f80,0x248dbf80,0xa50d8000,0xa50d8000,0xbf803f80,0xbf803f80
  .long 0xbf808000,0x3f80a50d,0x248d3f80,0xa554bf80,0x80008000,0x80008000,0x3f803f80,0x3f803f80
  .long 0x3f6d3ec4,0xbf6dbec4,0xbec43f6d,0x3ec4bf6d,0xbf353f35,0xbf353f35,0xbf353f35,0xbf353f35
  .long 0xbec43f6d,0x3ec4bf6d,0x3f6d3ec4,0xbf6dbec4,0x3f803f80,0x3f803f80,0xa554a554,0xa554a554
  .long 0xbec43f6d,0x3ec4bf6d,0xbf6dbec4,0x3f6d3ec4,0xbf353f35,0xbf353f35,0x3f35bf35,0x3f35bf35
  .long 0x3f6d3ec4,0xbf6dbec4,0x3ec4bf6d,0xbec43f6d,0xa50da50d,0xa50da50d,0xbf80bf80,0xbf80bf80
  .long 0xbf6dbec4,0x3f6d3ec4,0x3ec4bf6d,0xbec43f6d,0x3f35bf35,0x3f35bf35,0x3f35bf35,0x3f35bf35
  .long 0x3ec4bf6d,0xbec43f6d,0xbf6dbec4,0x3f6d3ec4,0xbf80bf80,0xbf80bf80,0x248d248d,0x248d248d
  .long 0x3ec4bf6d,0xbec43f6d,0x3f6d3ec4,0xbf6dbec4,0x3f35bf35,0x3f35bf35,0xbf353f35,0xbf353f35
  .long 0xbf6dbec4,0x3f6d3ec4,0xbec43f6d,0x3ec4bf6d,0x80008000,0x80008000,0x3f803f80,0x3f803f80
  .long 0x3f353f35,0xbf35bf35,0xbf353f35,0x3f35bf35,0xbf803f80,0xbf803f80,0x248da554,0x248da554
  .long 0x3f353f35,0xbf35bf35,0x3f35bf35,0xbf353f35,0xa50da50d,0xa50da50d,0xbf80bf80,0xbf80bf80
  .long 0xbf35bf35,0x3f353f35,0x3f35bf35,0xbf353f35,0x3f80bf80,0x3f80bf80,0xa554248d,0xa554248d
  .long 0xbf35bf35,0x3f353f35,0xbf353f35,0x3f35bf35,0x80008000,0x80008000,0x3f803f80,0x3f803f80
  .long 0x3f353f35,0xbf35bf35,0xbf353f35,0x3f35bf35,0xbf803f80,0xbf803f80,0x248da554,0x248da554
  .long 0x3f353f35,0xbf35bf35,0x3f35bf35,0xbf353f35,0xa50da50d,0xa50da50d,0xbf80bf80,0xbf80bf80
  .long 0xbf35bf35,0x3f353f35,0x3f35bf35,0xbf353f35,0x3f80bf80,0x3f80bf80,0xa554248d,0xa554248d
  .long 0xbf35bf35,0x3f353f35,0xbf353f35,0x3f35bf35,0x80008000,0x80008000,0x3f803f80,0x3f803f80
  .long 0x3ec43f6d,0xbec4bf6d,0xbf6d3ec4,0x3f6dbec4,0xbf353f35,0xbf353f35,0x3f35bf35,0x3f35bf35
  .long 0x3f6dbec4,0xbf6d3ec4,0xbec4bf6d,0x3ec43f6d,0xbf80bf80,0xbf80bf80,0x248d248d,0x248d248d
  .long 0x3f6dbec4,0xbf6d3ec4,0x3ec43f6d,0xbec4bf6d,0xbf353f35,0xbf353f35,0xbf353f35,0xbf353f35
  .long 0x3ec43f6d,0xbec4bf6d,0x3f6dbec4,0xbf6d3ec4,0xa50da50d,0xa50da50d,0xbf80bf80,0xbf80bf80
  .long 0xbec4bf6d,0x3ec43f6d,0x3f6dbec4,0xbf6d3ec4,0x3f35bf35,0x3f35bf35,0xbf353f35,0xbf353f35
  .long 0xbf6d3ec4,0x3f6dbec4,0x3ec43f6d,0xbec4bf6d,0x3f803f80,0x3f803f80,0xa554a554,0xa554a554
  .long 0xbf6d3ec4,0x3f6dbec4,0xbec4bf6d,0x3ec43f6d,0x3f35bf35,0x3f35bf35,0x3f35bf35,0x3f35bf35
  .long 0xbec4bf6d,0x3ec43f6d,0xbf6d3ec4,0x3f6dbec4,0x80008000,0x80008000,0x3f803f80,0x3f803f80
  .long 0x80008000,0x80008000,0x3f803f80,0x3f803f80,0x3f808000,0xbf80a50d,0xa5543f80,0x248dbf80
  .long 0xa50d8000,0xa50d8000,0xbf803f80,0xbf803f80,0xbf808000,0x3f80a50d,0x248d3f80,0xa554bf80
  .long 0x80008000,0x80008000,0x3f803f80,0x3f803f80,0x3f808000,0xbf80a50d,0xa5543f80,0x248dbf80
  .long 0xa50d8000,0xa50d8000,0xbf803f80,0xbf803f80,0xbf808000,0x3f80a50d,0x248d3f80,0xa554bf80
  .long 0x80008000,0x80008000,0x3f803f80,0x3f803f80,0x3f808000,0xbf80a50d,0xa5543f80,0x248dbf80
  .long 0xa50d8000,0xa50d8000,0xbf803f80,0xbf803f80,0xbf808000,0x3f80a50d,0x248d3f80,0xa554bf80
  .long 0x80008000,0x80008000,0x3f803f80,0x3f803f80,0x3f808000,0xbf80a50d,0xa5543f80,0x248dbf80
  .long 0xa50d8000,0xa50d8000,0xbf803f80,0xbf803f80,0xbf808000,0x3f80a50d,0x248d3f80,0xa554bf80
  .long 0x80008000,0x80008000,0x3f803f80,0x3f803f80,0x3f6d3ec4,0xbf6dbec4,0xbec43f6d,0x3ec4bf6d
  .long 0xbf353f35,0xbf353f35,0xbf353f35,0xbf353f35,0xbec43f6d,0x3ec4bf6d,0x3f6d3ec4,0xbf6dbec4
  .long 0x3f803f80,0x3f803f80,0xa554a554,0xa554a554,0xbec43f6d,0x3ec4bf6d,0xbf6dbec4,0x3f6d3ec4
  .long 0xbf353f35,0xbf353f35,0x3f35bf35,0x3f35bf35,0x3f6d3ec4,0xbf6dbec4,0x3ec4bf6d,0xbec43f6d
  .long 0xa50da50d,0xa50da50d,0xbf80bf80,0xbf80bf80,0xbf6dbec4,0x3f6d3ec4,0x3ec4bf6d,0xbec43f6d
  .long 0x3f35bf35,0x3f35bf35,0x3f35bf35,0x3f35bf35,0x3ec4bf6d,0xbec43f6d,0xbf6dbec4,0x3f6d3ec4
  .long 0xbf80bf80,0xbf80bf80,0x248d248d,0x248d248d,0x3ec4bf6d,0xbec43f6d,0x3f6d3ec4,0xbf6dbec4
  .long 0x3f35bf35,0x3f35bf35,0xbf353f35,0xbf353f35,0xbf6dbec4,0x3f6d3ec4,0xbec43f6d,0x3ec4bf6d
  .long 0x80008000,0x80008000,0x3f803f80,0x3f803f80,0x3f353f35,0xbf35bf35,0xbf353f35,0x3f35bf35
  .long 0xbf803f80,0xbf803f80,0x248da554,0x248da554,0x3f353f35,0xbf35bf35,0x3f35bf35,0xbf353f35
  .long 0xa50da50d,0xa50da50d,0xbf80bf80,0xbf80bf80,0xbf35bf35,0x3f353f35,0x3f35bf35,0xbf353f35
  .long 0x3f80bf80,0x3f80bf80,0xa554248d,0xa554248d,0xbf35bf35,0x3f353f35,0xbf353f35,0x3f35bf35
  .long 0x80008000,0x80008000,0x3f803f80,0x3f803f80,0x3f353f35,0xbf35bf35,0xbf353f35,0x3f35bf35
  .long 0xbf803f80,0xbf803f80,0x248da554,0x248da554,0x3f353f35,0xbf35bf35,0x3f35bf35,0xbf353f35
  .long 0xa50da50d,0xa50da50d,0xbf80bf80,0xbf80bf80,0xbf35bf35,0x3f353f35,0x3f35bf35,0xbf353f35
  .long 0x3f80bf80,0x3f80bf80,0xa554248d,0xa554248d,0xbf35bf35,0x3f353f35,0xbf353f35,0x3f35bf35
  .long 0x80008000,0x80008000,0x3f803f80,0x3f803f80,0x3ec43f6d,0xbec4bf6d,0xbf6d3ec4,0x3f6dbec4
  .long 0xbf353f35,0xbf353f35,0x3f35bf35,0x3f35bf35,0x3f6dbec4,0xbf6d3ec4,0xbec4bf6d,0x3ec43f6d
  .long 0xbf80bf80,0xbf80bf80,0x248d248d,0x248d248d,0x3f6dbec4,0xbf6d3ec4,0x3ec43f6d,0xbec4bf6d
  .long 0xbf353f35,0xbf353f35,0xbf353f35,0xbf353f35,0x3ec43f6d,0xbec4bf6d,0x3f6dbec4,0xbf6d3ec4
  .long 0xa50da50d,0xa50da50d,0xbf80bf80,0xbf80bf80,0xbec4bf6d,0x3ec43f6d,0x3f6dbec4,0xbf6d3ec4
  .long 0x3f35bf35,0x3f35bf35,0xbf353f35,0xbf353f35,0xbf6d3ec4,0x3f6dbec4,0x3ec43f6d,0xbec4bf6d
  .long 0x3f803f80,0x3f803f80,0xa554a554,0xa554a554,0xbf6d3ec4,0x3f6dbec4,0xbec4bf6d,0x3ec43f6d
  .long 0x3f35bf35,0x3f35bf35,0x3f35bf35,0x3f35bf35,0xbec4bf6d,0x3ec43f6d,0xbf6d3ec4,0x3f6dbec4
fnet_tables_end:
```
